```python
import torch

def _softmax(x, axis=-1):
    return torch.softmax(x, dim=axis)

def _gelu(x):
    return torch.nn.functional.gelu(x, approximate='tanh')

def _silu(x):
    return torch.nn.functional.silu(x)

def _sigmoid(x):
    return torch.sigmoid(x)

def _layernorm(x, axis=-1, eps=1e-05):
    m = x.mean(dim=axis, keepdim=True)
    v = x.var(dim=axis, keepdim=True, unbiased=False)
    return (x - m) / torch.sqrt(v + eps)

def _scatter_add(tgt, idx, src, axis=0):
    return tgt.clone().index_add_(axis, idx, src)

def _segment_sum(src, seg, n):
    out = torch.zeros((n,) + src.shape[1:], dtype=src.dtype)
    return out.index_add_(0, seg, src)

def _pad(x, pw):
    flat = tuple((v for pair in reversed(pw) for v in pair))
    return torch.nn.functional.pad(x, flat)
kernel_name = 'adaLN_cond__sliding_block__dense_activation_squared_relu__prompt'

def setup_inputs():

    _w = lambda a: (lambda t: t.to(torch.bfloat16) if t.is_floating_point() else t)(torch.as_tensor(a))

    def _A_setup():
        B, S, D = (1, 2048, 448)
        return {'x': _w((lambda *s: torch.randn(*s, dtype=torch.bfloat16) * 0.05)(B, S, D)), 'wqkv': _w((lambda *s: torch.randn(*s, dtype=torch.bfloat16) * 0.05)(D, 3 * D)), 'wo': _w((lambda *s: torch.randn(*s, dtype=torch.bfloat16) * 0.05)(D, D))}
    _A_in = _A_setup()

    def _B_setup():
        B, S, D, F = (1, 2048, 448, 1792)
        return {'x': _w((lambda *s: torch.randn(*s, dtype=torch.bfloat16) * 0.05)(B, S, D)), 'w1': _w((lambda *s: torch.randn(*s, dtype=torch.bfloat16) * 0.05)(D, F)), 'b1': _w((lambda *s: torch.randn(*s, dtype=torch.bfloat16) * 0.4)(F)), 'w2': _w((lambda *s: torch.randn(*s, dtype=torch.bfloat16) * 0.05)(F, D)), 'b2': _w((lambda *s: torch.randn(*s, dtype=torch.bfloat16) * 3.2)(D))}
    _B_in = _B_setup()
    return {'A_x': _A_in['x'], 'A_wqkv': _A_in['wqkv'], 'A_wo': _A_in['wo'], 'B_x': _B_in['x'], 'B_w1': _B_in['w1'], 'B_b1': _B_in['b1'], 'B_w2': _B_in['w2'], 'B_b2': _B_in['b2'], 'c': _w((lambda *s: torch.randn(*s, dtype=torch.bfloat16) * 0.1)(1, 448) * 8.0), 'w_mod': _w((lambda *s: torch.randn(*s, dtype=torch.bfloat16) * 0.1)(448, 6 * 448) * 448 ** (-0.5) * 8.0)}

def reference(A_x, A_wqkv, A_wo, B_x, B_w1, B_b1, B_w2, B_b2, c, w_mod):

    def _A_ref(x, wqkv, wo):
        B, S, D = x.shape
        H = 16
        Dh = D // H
        W = 256
        qkv = (lambda x, *d: x.permute(*d))((x @ wqkv).reshape(B, S, 3, H, Dh), 2, 0, 3, 1, 4)
        q, k, v = (qkv[0], qkv[1], qkv[2])
        scores = torch.einsum('bhqd,bhkd->bhqk', q, k) * Dh ** (-0.5)
        idx = torch.arange(S)
        mask = (idx[:, None] - idx[None, :] >= 0) & (idx[:, None] - idx[None, :] < W)
        scores = torch.where(mask[None, None], scores, -1000000000.0)
        p = _softmax(scores, axis=-1)
        o = torch.einsum('bhqk,bhkd->bhqd', p, v)
        return (lambda x, *d: x.permute(*d))(o, 0, 2, 1, 3).reshape(B, S, D) @ wo

    def _B_ref(x, w1, b1, w2, b2):
        h = torch.einsum('bsd,df->bsf', x, w1) + b1
        zero = torch.zeros_like(h)
        r = torch.where(h > zero, h, zero)
        h = r * r
        out = torch.einsum('bsf,fd->bsd', h, w2) + b2
        return out
    x = A_x
    mod = (_silu(c) @ w_mod).reshape(c.shape[0], 6, 1, -1)
    sa, ca, ga, sb, cb, gb = (mod[:, 0].clone(), mod[:, 1].clone(), mod[:, 2].clone(), mod[:, 3].clone(), mod[:, 4].clone(), mod[:, 5].clone())
    h = _layernorm(x, axis=-1) * (1 + ca) + sa
    x = x + ga * _A_ref(h, A_wqkv, A_wo)
    h = _layernorm(x, axis=-1) * (1 + cb) + sb
    x = x + gb * _B_ref(h, B_w1, B_b1, B_w2, B_b2)
    return x
```

```asm
; @launch grid=(256,1,1) block=(256,1,1) lds=163840
.amdgcn_target "amdgcn-amd-amdhsa--gfx950"
.text
.globl adaLN_cond__sliding_block__dense_activation_squared_relu__prompt_kernel
.p2align 12
.p2align 8
.type adaLN_cond__sliding_block__dense_activation_squared_relu__prompt_kernel,@function
adaLN_cond__sliding_block__dense_activation_squared_relu__prompt_kernel:
  s_cmp_ge_u32 s2, 256
  s_cbranch_scc1 L_exit
  s_load_dwordx2 s[48:49], s[0:1], 96
  s_load_dwordx2 s[36:37], s[0:1], 64
  s_load_dwordx2 s[40:41], s[0:1], 72
  s_load_dwordx2 s[8:9], s[0:1], 0
  s_load_dwordx2 s[12:13], s[0:1], 8
  s_load_dwordx2 s[44:45], s[0:1], 80
  s_getpc_b64 s[52:53]
L_codebase:
  s_mov_b32 s54, L_hotend-L_codebase
  s_mov_b32 s55, 0x20000
  v_lshlrev_b32 v1, 3, v0
  s_lshr_b32 s61, s2, 3
  s_lshl_b32 s61, s61, 11
  s_mov_b32 exec_lo, 65537
  s_mov_b32 exec_hi, 65537
  buffer_load_dword v248, v1, s[52:55], s61 offen
  s_mov_b64 exec, -1
  v_lshrrev_b32 v1, 6, v0
  v_and_b32 v0, 63, v0
  v_readfirstlane_b32 s3, v1
  s_mov_b32 s10, 1835008
  s_mov_b32 s11, 0x20000
  s_mov_b32 s14, 1204224
  s_mov_b32 s15, 0x20000
  s_mov_b32 s38, 896
  s_mov_b32 s39, 0x20000
  s_mov_b32 s42, 2408448
  s_mov_b32 s43, 0x20000
  s_mov_b32 s50, 18874368
  s_mov_b32 s51, 0x20000
  s_mov_b32 s46, 1835008
  s_mov_b32 s47, 0x20000
  s_and_b32 s61, s2, 7
  s_lshr_b32 s69, s2, 3
  s_lshr_b32 s63, s69, 4
  s_mul_i32 s5, s63, 2
  s_add_u32 s5, s5, s69
  s_and_b32 s5, s5, 15
  s_lshl4_add_u32 s69, s63, s5
  s_lshr_b32 s4, s61, 2
  s_mul_i32 s4, s4, 0
  s_xor_b32 s4, s4, s61
  s_lshl1_add_u32 s4, s4, s63
  s_bitcmp1_b32 0x5ab, s5
  s_cselect_b32 s75, s61, 7
  s_bfm_b32 s62, s5, 0
  s_and_b32 s62, s62, 0x5ab
  s_bcnt1_i32_b32 s62, s62
  s_mov_b32 s76, s62
  s_mul_i32 s63, s63, 7
  s_add_u32 s77, s62, s63
  v_lshlrev_b32 v2, 4, v0
  s_lshl3_add_u32 s62, s4, s62
  s_mul_i32 s70, s62, 14336
  s_mul_i32 s62, s3, 224
  s_add_u32 s70, s70, s62
  v_and_b32 v240, 7, v0
  v_lshrrev_b32 v241, 3, v0
  v_lshlrev_b32 v240, 4, v240
  v_lshl_add_u32 v10, v241, 9, v240
  v_lshrrev_b32 v240, 2, v0
  v_mul_u32_u24 v240, 2688, v240
  v_and_b32 v242, 3, v0
  v_lshlrev_b32 v242, 4, v242
  v_lshl_add_u32 v11, v240, 1, v242
  v_min_u32 v242, 40, v242
  v_add_u32 v7, v242, v240
  v_lshlrev_b32 v243, 2, v0
  s_mul_i32 s73, s3, 43008
  s_mul_i32 s62, s5, 56
  s_add_u32 s73, s73, s62
  s_lshl_b32 s74, s3, 10
  s_lshl_b32 s60, s4, 20
  s_add_u32 s60, s60, 2097152
  s_lshr_b32 s62, s76, 1
  s_lshl2_add_u32 s71, s4, s62
  s_mul_i32 s71, s71, 28672
  s_mul_i32 s57, s3, 7168
  v_add_u32 v10, s57, v10
  s_mul_i32 s58, s62, 1024
  v_xor_b32 v10, s58, v10
  s_and_b32 s63, s76, 1
  s_lshl_b32 s64, s63, 8
  s_add_u32 s71, s71, s64
  s_lshl2_add_u32 s63, s63, s3
  s_lshl4_add_u32 s72, s62, s63
  s_lshl2_add_u32 s72, s72, s60
  s_add_u32 s72, s72, 522752
  s_mov_b32 s59, 0
  s_mov_b32 s56, 0
  v_lshrrev_b32 v245, 4, v0
  v_mul_u32_u24 v245, 896, v245
  v_and_b32 v246, 15, v0
  v_min_u32 v246, 13, v246
  v_lshl_add_u32 v12, v246, 4, v245
  s_lshl_b32 s67, s3, 12
  v_lshlrev_b32 v254, 7, v0
  s_and_b32 s62, s4, 1
  s_mul_i32 s62, s62, 12288
  s_bitcmp1_b32 0xd5ab, s5
  s_cselect_b32 s63, 8192, 0
  s_add_u32 s62, s62, s63
  s_add_u32 s74, s74, s62
  s_mul_i32 s62, s62, 42
  s_add_u32 s73, s73, s62
  s_and_b32 s61, s2, 7
  s_sub_u32 s64, s69, s77
  s_cmp_lt_u32 s64, 16
  s_cselect_b32 s68, s61, 7
  s_lshl2_add_u32 s64, s64, s3
  s_mul_i32 s64, s64, 37632
  s_mul_i32 s61, s61, 896
  s_add_u32 s64, s64, s61
  v_mul_u32_u24 v240, 5376, v241
  v_and_b32 v242, 7, v0
  v_lshl_add_u32 v240, v242, 7, v240
  s_lshl2_add_u32 s69, s2, s3
  s_mul_i32 s69, s69, 1280
  s_lshl_b32 s65, s3, 13
  s_add_u32 s65, s65, 114688
  s_mul_i32 s62, s3, 688128
  s_add_u32 s62, s62, s61
  s_lshl_b32 s63, s77, 6
  s_add_u32 s62, s62, s63
  s_lshl_b32 s63, s3, 8
  s_cmp_ge_u32 s75, 2
  s_waitcnt lgkmcnt(0)
  s_load_dword s6, s[48:49], 0
  s_cbranch_scc1 L_nomod1
  buffer_load_dword v244, v243, s[36:39], s63 offen
  s_add_u32 m0, s65, 0
  s_add_u32 s61, s62, 0
  buffer_load_dwordx4 v11, s[40:43], s61 offen  lds
  s_add_u32 m0, s65, 1024
  s_add_u32 s61, s62, 86016
  buffer_load_dwordx4 v11, s[40:43], s61 offen  lds
  s_add_u32 m0, s65, 2048
  s_add_u32 s61, s62, 172032
  buffer_load_dwordx4 v11, s[40:43], s61 offen  lds
  s_add_u32 m0, s65, 3072
  s_add_u32 s61, s62, 258048
  buffer_load_dwordx4 v11, s[40:43], s61 offen  lds
  s_add_u32 m0, s65, 4096
  s_add_u32 s61, s62, 344064
  buffer_load_dwordx4 v11, s[40:43], s61 offen  lds
  s_add_u32 m0, s65, 5120
  s_add_u32 s61, s62, 430080
  buffer_load_dwordx4 v11, s[40:43], s61 offen  lds
  s_add_u32 m0, s65, 6144
  s_add_u32 s61, s62, 516096
  buffer_load_dwordx4 v11, s[40:43], s61 offen  lds
  s_add_u32 m0, s65, 7168
  s_add_u32 s61, s62, 602112
  buffer_load_dwordx4 v11, s[40:43], s61 offen  lds
  s_branch L_nomod1b
L_nomod1:
  s_cmp_ge_u32 s68, 2
  s_cbranch_scc1 L_nomod1b
  s_mov_b32 exec_lo, 0x7f7f7f7f
  s_mov_b32 exec_hi, 0x7f7f7f
  buffer_load_dword v248, v240, s[40:43], s64 offen
  s_mov_b64 exec, -1
L_nomod1b:
  s_bitcmp1_b32 0x15ab, s5
  s_cbranch_scc0 L_nox
  s_add_u32 m0, s67, 86016
  s_add_u32 s61, s70, 0
  buffer_load_dwordx4 v12, s[8:11], s61 offen  lds
  s_add_u32 m0, s67, 87040
  s_add_u32 s61, s70, 3584
  buffer_load_dwordx4 v12, s[8:11], s61 offen  lds
  s_add_u32 m0, s67, 88064
  s_add_u32 s61, s70, 7168
  buffer_load_dwordx4 v12, s[8:11], s61 offen  lds
  s_add_u32 m0, s67, 89088
  s_add_u32 s61, s70, 10752
  buffer_load_dwordx4 v12, s[8:11], s61 offen  lds
L_nox:
  s_cmp_lt_u32 s75, 2
  s_cbranch_scc1 L_nob0
  s_mov_b64 exec, 0x3ff
  buffer_load_dword v248, v254, s[12:15], s69 offen
  s_mov_b64 exec, -1
  s_add_u32 m0, s74, 0
  s_add_u32 s61, s73, 896
  buffer_load_dwordx4 v7, s[12:15], s61 offen  lds
  s_add_u32 m0, s74, 28672
  s_add_u32 s61, s73, 1792
  buffer_load_dwordx4 v7, s[12:15], s61 offen  lds
  s_add_u32 m0, s74, 57344
  s_add_u32 s61, s73, 0
  buffer_load_dwordx4 v7, s[12:15], s61 offen  lds
  s_add_u32 s73, s73, 172032
  s_add_u32 s74, s74, 4096
  s_add_u32 s59, s59, 1
  s_cmp_ge_u32 s74, 28672
  s_cselect_b32 s61, 28672, 0
  s_sub_u32 s74, s74, s61
  s_mul_i32 s61, s61, 42
  s_sub_u32 s73, s73, s61
  s_add_u32 m0, s74, 0
  s_add_u32 s61, s73, 896
  buffer_load_dwordx4 v7, s[12:15], s61 offen  lds
  s_add_u32 m0, s74, 28672
  s_add_u32 s61, s73, 1792
  buffer_load_dwordx4 v7, s[12:15], s61 offen  lds
  s_add_u32 m0, s74, 57344
  s_add_u32 s61, s73, 0
  buffer_load_dwordx4 v7, s[12:15], s61 offen  lds
  s_add_u32 s73, s73, 172032
  s_add_u32 s74, s74, 4096
  s_add_u32 s59, s59, 1
  s_cmp_ge_u32 s74, 28672
  s_cselect_b32 s61, 28672, 0
  s_sub_u32 s74, s74, s61
  s_mul_i32 s61, s61, 42
  s_sub_u32 s73, s73, s61
L_nob0:
  s_load_dwordx2 s[16:17], s[0:1], 16
  s_load_dwordx2 s[20:21], s[0:1], 32
  s_load_dwordx2 s[24:25], s[0:1], 40
  s_load_dwordx2 s[28:29], s[0:1], 48
  s_load_dwordx2 s[32:33], s[0:1], 56
  v_mov_b32 v20, 0
  v_mov_b32 v21, 0
  v_mov_b32 v22, 0
  v_mov_b32 v23, 0
  v_mov_b32 v132, 0
  v_mov_b32 v133, 0
  v_mov_b32 v134, 0
  v_mov_b32 v135, 0
  s_mov_b32 s18, 401408
  s_mov_b32 s19, 0x20000
  s_mov_b32 s22, 1605632
  s_mov_b32 s23, 0x20000
  s_mov_b32 s26, 3584
  s_mov_b32 s27, 0x20000
  s_mov_b32 s30, 1605632
  s_mov_b32 s31, 0x20000
  s_mov_b32 s34, 896
  s_mov_b32 s35, 0x20000
  s_cmp_ge_u32 s5, 7
  s_cselect_b32 s66, 1, 0
  s_mul_i32 s62, s66, 7
  s_sub_u32 s67, s5, s62
  v_lshrrev_b32 v241, 5, v0
  v_bfe_u32 v240, v0, 2, 2
  v_lshl_add_u32 v240, v241, 3, v240
  v_lshlrev_b32 v240, 6, v240
  v_and_b32 v242, 3, v0
  v_lshl_add_u32 v240, v242, 3, v240
  v_bfe_u32 v242, v0, 4, 1
  v_lshl_add_u32 v8, v242, 5, v240
  v_bfe_u32 v240, v0, 1, 1
  v_and_b32 v240, v240, v242
  v_lshlrev_b32 v240, 3, v240
  v_xor_b32 v8, v8, v240
  v_add_u32 v9, 57344, v8
  v_lshrrev_b32 v240, 3, v0
  v_mul_u32_u24 v240, 896, v240
  v_lshlrev_b32 v242, 2, v242
  v_and_b32 v241, 7, v0
  v_xor_b32 v241, v241, v242
  v_lshl_add_u32 v1, v241, 4, v240
  s_waitcnt lgkmcnt(0)
  s_mul_i32 s6, s6, 0x9E3779B5
  s_add_u32 s6, s6, 0x7F4A7C15
  s_getreg_b32 s7, hwreg(HW_REG_XCC_ID, 0, 4)
  v_mov_b32 v3, s6
  s_cmp_eq_u32 s3, 3
  s_cbranch_scc0 L_w_1
  s_lshl4_add_u32 s62, s4, s5
  s_lshl_b32 s62, s62, 7
  s_add_u32 s62, s62, 32768
  v_mov_b32 v252, s7
  v_mov_b32 v253, s6
  s_mov_b64 exec, 1
  buffer_store_dwordx2 v[252:253], off, s[48:51], s62 sc1
  s_mov_b64 exec, -1
L_w_1:
  s_bitcmp1_b32 0x15ab, s5
  s_cbranch_scc0 L_nonh
  s_cmp_ge_u32 s75, 2
  s_cbranch_scc1 L_nomod2
  s_lshl_b32 s61, s3, 8
  s_add_u32 s61, s61, 155648
  v_add_u32 v243, s61, v243
  s_waitcnt vmcnt(12)
  v_lshlrev_b32 v245, 16, v244
  v_and_b32 v246, 0xffff0000, v244
  v_mul_f32 v247, 0xbfb8aa3b, v245
  v_mul_f32 v244, 0xbfb8aa3b, v246
  v_exp_f32 v247, v247
  v_exp_f32 v244, v244
  v_lshrrev_b32 v240, 4, v0
  v_add_f32 v247, 1.0, v247
  v_add_f32 v244, 1.0, v244
  v_rcp_f32 v247, v247
  v_rcp_f32 v244, v244
  v_lshl_add_u32 v241, v240, 4, s61
  v_mul_f32 v245, v245, v247
  v_mul_f32 v246, v246, v244
  v_cvt_pk_bf16_f32 v244, v245, v246
  ds_write_b32 v243, v244
  ds_read_b128 v[64:67], v241 offset:0
  ds_read_b128 v[68:71], v241 offset:64
  ds_read_b128 v[72:75], v241 offset:128
  ds_read_b128 v[76:79], v241 offset:192
  v_bfe_u32 v242, v0, 2, 2
  v_lshl_add_u32 v242, v240, 3, v242
  v_lshlrev_b32 v242, 6, v242
  v_and_b32 v249, 3, v0
  v_lshl_add_u32 v242, v249, 3, v242
  v_add_u32 v242, s65, v242
  s_lshl_b32 s61, s3, 7
  s_add_u32 s61, s61, 156672
  v_lshl_add_u32 v251, v240, 4, s61
  v_and_b32 v249, 0x70, v2
  v_add_u32 v250, 156672, v249
  s_waitcnt vmcnt(4)
  ds_read_b64_tr_b16 v[96:97], v242 offset:0
  ds_read_b64_tr_b16 v[98:99], v242 offset:256
  ds_read_b64_tr_b16 v[100:101], v242 offset:32
  ds_read_b64_tr_b16 v[102:103], v242 offset:288
  ds_read_b64_tr_b16 v[104:105], v242 offset:2048
  ds_read_b64_tr_b16 v[106:107], v242 offset:2304
  ds_read_b64_tr_b16 v[108:109], v242 offset:2080
  ds_read_b64_tr_b16 v[110:111], v242 offset:2336
  ds_read_b64_tr_b16 v[112:113], v242 offset:4096
  ds_read_b64_tr_b16 v[114:115], v242 offset:4352
  ds_read_b64_tr_b16 v[116:117], v242 offset:4128
  ds_read_b64_tr_b16 v[118:119], v242 offset:4384
  ds_read_b64_tr_b16 v[120:121], v242 offset:6144
  ds_read_b64_tr_b16 v[122:123], v242 offset:6400
  ds_read_b64_tr_b16 v[124:125], v242 offset:6176
  ds_read_b64_tr_b16 v[126:127], v242 offset:6432
  s_waitcnt lgkmcnt(14)
  v_mfma_f32_16x16x32_bf16 v[80:83], v[96:99], v[64:67], 0
  s_waitcnt lgkmcnt(12)
  v_mfma_f32_16x16x32_bf16 v[84:87], v[100:103], v[64:67], 0
  s_waitcnt lgkmcnt(10)
  v_mfma_f32_16x16x32_bf16 v[80:83], v[104:107], v[68:71], v[80:83]
  s_waitcnt lgkmcnt(8)
  v_mfma_f32_16x16x32_bf16 v[84:87], v[108:111], v[68:71], v[84:87]
  s_waitcnt lgkmcnt(6)
  v_mfma_f32_16x16x32_bf16 v[80:83], v[112:115], v[72:75], v[80:83]
  s_waitcnt lgkmcnt(4)
  v_mfma_f32_16x16x32_bf16 v[84:87], v[116:119], v[72:75], v[84:87]
  s_waitcnt lgkmcnt(2)
  v_mfma_f32_16x16x32_bf16 v[80:83], v[120:123], v[76:79], v[80:83]
  s_waitcnt lgkmcnt(0)
  v_mfma_f32_16x16x32_bf16 v[84:87], v[124:127], v[76:79], v[84:87]
  s_cmp_eq_u32 s75, 1
  s_cselect_b32 s62, 1.0, 0
  s_lshl4_add_u32 s63, s75, s77
  s_lshl_b32 s63, s63, 7
  s_add_u32 s63, s63, 8192
  s_nop 0
  ds_write_b128 v251, v[80:83]
  s_nop 0
  ds_write_b128 v251, v[84:87] offset:64
  s_waitcnt lgkmcnt(0)
  s_barrier
  s_waitcnt vmcnt(0)
  s_cmp_lg_u32 s3, 0
  s_cbranch_scc1 L_nomod2
  ds_read_b128 v[64:67], v250 offset:0
  ds_read_b128 v[68:71], v250 offset:128
  ds_read_b128 v[72:75], v250 offset:256
  ds_read_b128 v[76:79], v250 offset:384
  v_mov_b32 v82, s6
  v_mov_b32 v83, s6
  s_waitcnt lgkmcnt(2)
  v_pk_add_f32 v[64:65], v[64:65], v[68:69]
  v_pk_add_f32 v[66:67], v[66:67], v[70:71]
  s_waitcnt lgkmcnt(0)
  v_pk_add_f32 v[72:73], v[72:73], v[76:77]
  v_pk_add_f32 v[74:75], v[74:75], v[78:79]
  v_pk_add_f32 v[64:65], v[64:65], v[72:73]
  v_pk_add_f32 v[66:67], v[66:67], v[74:75]
  v_cvt_pk_bf16_f32 v80, v64, v65
  v_cvt_pk_bf16_f32 v81, v66, v67
  v_lshlrev_b32 v64, 16, v80
  v_and_b32 v65, 0xffff0000, v80
  v_lshlrev_b32 v66, 16, v81
  v_and_b32 v67, 0xffff0000, v81
  v_add_f32 v64, s62, v64
  v_add_f32 v65, s62, v65
  v_add_f32 v66, s62, v66
  v_add_f32 v67, s62, v67
  v_cvt_pk_bf16_f32 v80, v64, v65
  v_cvt_pk_bf16_f32 v81, v66, v67
  s_mov_b64 exec, 0xff
  buffer_store_dwordx4 v[80:83], v2, s[48:51], s63 offen sc1
  s_mov_b64 exec, -1
L_nomod2:
  s_cmp_lt_u32 s75, 2
  s_cbranch_scc1 L_xok
  s_waitcnt vmcnt(7)
  s_add_u32 m0, s74, 0
  s_add_u32 s61, s73, 896
  buffer_load_dwordx4 v7, s[12:15], s61 offen  lds
  s_add_u32 m0, s74, 28672
  s_add_u32 s61, s73, 1792
  buffer_load_dwordx4 v7, s[12:15], s61 offen  lds
  s_add_u32 m0, s74, 57344
  s_add_u32 s61, s73, 0
  buffer_load_dwordx4 v7, s[12:15], s61 offen  lds
  s_add_u32 s73, s73, 172032
  s_add_u32 s74, s74, 4096
  s_add_u32 s59, s59, 1
  s_cmp_ge_u32 s74, 28672
  s_cselect_b32 s61, 28672, 0
  s_sub_u32 s74, s74, s61
  s_mul_i32 s61, s61, 42
  s_sub_u32 s73, s73, s61
L_xok:
  v_and_b32 v240, 7, v0
  v_lshlrev_b32 v240, 8, v240
  v_lshrrev_b32 v242, 3, v0
  v_lshl_add_u32 v240, v242, 4, v240
  v_lshl_add_u32 v240, s3, 12, v240
  v_add_u32 v240, 86016, v240
  ds_read_b128 v[16:19], v240 offset:0
  ds_read_b128 v[128:131], v240 offset:2048
  s_lshr_b64 exec, -1, 16
  ds_read_b128 v[20:23], v240 offset:128
  ds_read_b128 v[132:135], v240 offset:2176
  s_mov_b64 exec, -1
  v_mov_b32 v12, 0
  v_mov_b32 v13, 0
  v_mov_b32 v14, 0
  v_mov_b32 v15, 0
  v_mov_b32 v56, 0x3f803f80
  s_waitcnt lgkmcnt(3)
  v_dot2c_f32_bf16 v12, v16, v56
  v_dot2c_f32_bf16 v13, v16, v16
  v_dot2c_f32_bf16 v12, v17, v56
  v_dot2c_f32_bf16 v13, v17, v17
  v_dot2c_f32_bf16 v12, v18, v56
  v_dot2c_f32_bf16 v13, v18, v18
  v_dot2c_f32_bf16 v12, v19, v56
  v_dot2c_f32_bf16 v13, v19, v19
  s_waitcnt lgkmcnt(1)
  v_dot2c_f32_bf16 v12, v20, v56
  v_dot2c_f32_bf16 v13, v20, v20
  v_dot2c_f32_bf16 v12, v21, v56
  v_dot2c_f32_bf16 v13, v21, v21
  v_dot2c_f32_bf16 v12, v22, v56
  v_dot2c_f32_bf16 v13, v22, v22
  v_dot2c_f32_bf16 v12, v23, v56
  v_dot2c_f32_bf16 v13, v23, v23
  v_dot2c_f32_bf16 v14, v128, v56
  v_dot2c_f32_bf16 v15, v128, v128
  v_dot2c_f32_bf16 v14, v129, v56
  v_dot2c_f32_bf16 v15, v129, v129
  v_dot2c_f32_bf16 v14, v130, v56
  v_dot2c_f32_bf16 v15, v130, v130
  v_dot2c_f32_bf16 v14, v131, v56
  v_dot2c_f32_bf16 v15, v131, v131
  s_waitcnt lgkmcnt(0)
  v_dot2c_f32_bf16 v14, v132, v56
  v_dot2c_f32_bf16 v15, v132, v132
  v_dot2c_f32_bf16 v14, v133, v56
  v_dot2c_f32_bf16 v15, v133, v133
  v_dot2c_f32_bf16 v14, v134, v56
  v_dot2c_f32_bf16 v15, v134, v134
  v_dot2c_f32_bf16 v14, v135, v56
  v_dot2c_f32_bf16 v15, v135, v135
  s_cmp_ge_u32 s75, 2
  s_cbranch_scc1 L_xp
  s_mov_b64 exec, 0x3ff
  buffer_load_dword v248, v254, s[12:15], s69 offen
  s_mov_b64 exec, -1
  s_add_u32 m0, s74, 0
  s_add_u32 s61, s73, 896
  buffer_load_dwordx4 v7, s[12:15], s61 offen  lds
  s_add_u32 m0, s74, 28672
  s_add_u32 s61, s73, 1792
  buffer_load_dwordx4 v7, s[12:15], s61 offen  lds
  s_add_u32 m0, s74, 57344
  s_add_u32 s61, s73, 0
  buffer_load_dwordx4 v7, s[12:15], s61 offen  lds
  s_add_u32 s73, s73, 172032
  s_add_u32 s74, s74, 4096
  s_add_u32 s59, s59, 1
  s_cmp_ge_u32 s74, 28672
  s_cselect_b32 s61, 28672, 0
  s_sub_u32 s74, s74, s61
  s_mul_i32 s61, s61, 42
  s_sub_u32 s73, s73, s61
  s_add_u32 m0, s74, 0
  s_add_u32 s61, s73, 896
  buffer_load_dwordx4 v7, s[12:15], s61 offen  lds
  s_add_u32 m0, s74, 28672
  s_add_u32 s61, s73, 1792
  buffer_load_dwordx4 v7, s[12:15], s61 offen  lds
  s_add_u32 m0, s74, 57344
  s_add_u32 s61, s73, 0
  buffer_load_dwordx4 v7, s[12:15], s61 offen  lds
  s_add_u32 s73, s73, 172032
  s_add_u32 s74, s74, 4096
  s_add_u32 s59, s59, 1
  s_cmp_ge_u32 s74, 28672
  s_cselect_b32 s61, 28672, 0
  s_sub_u32 s74, s74, s61
  s_mul_i32 s61, s61, 42
  s_sub_u32 s73, s73, s61
L_xp:
  s_nop 1
  v_and_b32 v240, 7, v0
  v_lshlrev_b32 v240, 4, v240
  v_permlane32_swap_b32 v12, v13
  v_permlane32_swap_b32 v14, v15
  v_add_f32 v12, v12, v13
  v_add_f32 v14, v14, v15
  v_add_u32 v240, 157184, v240
  v_lshrrev_b32 v242, 4, v0
  v_permlane16_swap_b32 v12, v14
  v_add_f32 v12, v12, v14
  v_lshl_add_u32 v242, v242, 7, v240
  v_lshl_add_u32 v242, s3, 2, v242
  v_add_f32_dpp v12, v12, v12 row_ror:8 row_mask:0xf bank_mask:0xf
  ds_write_b32 v242, v12
  v_lshrrev_b32 v241, 5, v0
  v_lshlrev_b32 v24, 16, v16
  v_and_b32 v25, 0xffff0000, v16
  v_lshlrev_b32 v26, 16, v17
  v_and_b32 v27, 0xffff0000, v17
  v_lshlrev_b32 v28, 16, v18
  v_and_b32 v29, 0xffff0000, v18
  v_lshlrev_b32 v30, 16, v19
  v_and_b32 v31, 0xffff0000, v19
  v_lshlrev_b32 v32, 16, v20
  v_and_b32 v33, 0xffff0000, v20
  v_lshlrev_b32 v34, 16, v21
  v_and_b32 v35, 0xffff0000, v21
  v_lshlrev_b32 v36, 16, v22
  v_and_b32 v37, 0xffff0000, v22
  v_lshlrev_b32 v38, 16, v23
  v_and_b32 v39, 0xffff0000, v23
  s_waitcnt lgkmcnt(0)
  s_barrier
  ds_read_b128 v[40:43], v240 offset:0
  ds_read_b128 v[44:47], v240 offset:128
  ds_read_b128 v[48:51], v240 offset:256
  ds_read_b128 v[52:55], v240 offset:384
  v_lshlrev_b32 v136, 16, v128
  v_and_b32 v137, 0xffff0000, v128
  v_lshlrev_b32 v138, 16, v129
  v_and_b32 v139, 0xffff0000, v129
  v_lshlrev_b32 v140, 16, v130
  v_and_b32 v141, 0xffff0000, v130
  v_lshlrev_b32 v142, 16, v131
  v_and_b32 v143, 0xffff0000, v131
  v_lshlrev_b32 v144, 16, v132
  v_and_b32 v145, 0xffff0000, v132
  v_lshlrev_b32 v146, 16, v133
  v_and_b32 v147, 0xffff0000, v133
  v_lshlrev_b32 v148, 16, v134
  v_and_b32 v149, 0xffff0000, v134
  v_lshlrev_b32 v150, 16, v135
  v_and_b32 v151, 0xffff0000, v135
  v_and_b32 v242, 31, v0
  v_min_u32 v242, 27, v242
  v_lshlrev_b32 v243, 4, v242
  v_lshl_add_u32 v243, v241, 11, v243
  s_lshl_b32 s61, s3, 9
  s_add_u32 s61, s61, 157696
  v_lshl_add_u32 v242, v242, 3, s61
  v_lshl_add_u32 v242, v241, 8, v242
  v_lshrrev_b32 v244, 3, v0
  v_lshl_add_u32 v244, v244, 4, s61
  s_waitcnt lgkmcnt(3)
  v_pk_add_f32 v[40:41], v[40:41], v[42:43]
  s_waitcnt lgkmcnt(2)
  v_pk_add_f32 v[44:45], v[44:45], v[46:47]
  s_waitcnt lgkmcnt(1)
  v_pk_add_f32 v[48:49], v[48:49], v[50:51]
  s_waitcnt lgkmcnt(0)
  v_pk_add_f32 v[52:53], v[52:53], v[54:55]
  v_add_f32 v12, v40, v41
  v_add_f32 v13, v44, v45
  v_add_f32 v14, v48, v49
  v_add_f32 v15, v52, v53
  v_mul_f32 v12, 0x3b124925, v12
  v_mul_f32 v13, 0x3b124925, v13
  v_mul_f32 v14, 0x3b124925, v14
  v_mul_f32 v15, 0x3b124925, v15
  v_fma_f32 v14, -v12, v12, v14
  v_fma_f32 v15, -v13, v13, v15
  v_max_f32 v14, 0, v14
  v_max_f32 v15, 0, v15
  v_add_f32 v14, 0x3727c5ac, v14
  v_add_f32 v15, 0x3727c5ac, v15
  v_rsq_f32 v14, v14
  v_rsq_f32 v15, v15
  s_mul_i32 s70, s3, 448
  s_add_u32 s70, s70, 8192
  v_mul_f32_e64 v12, -v12, v14
  v_mul_f32_e64 v13, -v13, v15
  v_and_b32 v249, 1, v0
  v_mul_u32_u24 v249, 128, v249
  v_lshrrev_b32 v250, 1, v0
  v_lshl_add_u32 v249, v250, 9, v249
  v_add_u32 v249, s57, v249
  s_mov_b64 exec, 0xfffffff
  buffer_load_dword v248, v249, s[44:47], s71 offen sc1
  s_mov_b64 exec, 1
  buffer_load_dword v248, off, s[48:51], s72 sc1
  s_mov_b64 exec, -1
  s_lshl3_add_u32 s62, s4, s76
  s_lshl2_add_u32 s62, s62, s3
  v_lshlrev_b32 v249, 7, v0
  s_mul_i32 s61, s62, 896
  s_add_u32 s61, s61, 0
  s_lshr_b64 exec, -1, 57
  buffer_load_dword v248, v249, s[16:19], s61 offen
  s_mul_i32 s61, s62, 3200
  s_add_u32 s61, s61, 0
  s_lshr_b64 exec, -1, 39
  buffer_load_dword v248, v249, s[20:23], s61 offen
  s_mov_b64 exec, -1
  v_pk_fma_f32 v[24:25], v[24:25], v[14:15], v[12:13] op_sel_hi:[1,0,0]
  v_pk_fma_f32 v[26:27], v[26:27], v[14:15], v[12:13] op_sel_hi:[1,0,0]
  v_pk_fma_f32 v[28:29], v[28:29], v[14:15], v[12:13] op_sel_hi:[1,0,0]
  v_pk_fma_f32 v[30:31], v[30:31], v[14:15], v[12:13] op_sel_hi:[1,0,0]
  v_pk_fma_f32 v[32:33], v[32:33], v[14:15], v[12:13] op_sel_hi:[1,0,0]
  v_pk_fma_f32 v[34:35], v[34:35], v[14:15], v[12:13] op_sel_hi:[1,0,0]
  v_pk_fma_f32 v[36:37], v[36:37], v[14:15], v[12:13] op_sel_hi:[1,0,0]
  v_pk_fma_f32 v[38:39], v[38:39], v[14:15], v[12:13] op_sel_hi:[1,0,0]
  v_pk_fma_f32 v[136:137], v[136:137], v[14:15], v[12:13] op_sel:[0,1,1] op_sel_hi:[1,1,1]
  v_pk_fma_f32 v[138:139], v[138:139], v[14:15], v[12:13] op_sel:[0,1,1] op_sel_hi:[1,1,1]
  v_pk_fma_f32 v[140:141], v[140:141], v[14:15], v[12:13] op_sel:[0,1,1] op_sel_hi:[1,1,1]
  v_pk_fma_f32 v[142:143], v[142:143], v[14:15], v[12:13] op_sel:[0,1,1] op_sel_hi:[1,1,1]
  v_pk_fma_f32 v[144:145], v[144:145], v[14:15], v[12:13] op_sel:[0,1,1] op_sel_hi:[1,1,1]
  v_pk_fma_f32 v[146:147], v[146:147], v[14:15], v[12:13] op_sel:[0,1,1] op_sel_hi:[1,1,1]
  v_pk_fma_f32 v[148:149], v[148:149], v[14:15], v[12:13] op_sel:[0,1,1] op_sel_hi:[1,1,1]
  v_pk_fma_f32 v[150:151], v[150:151], v[14:15], v[12:13] op_sel:[0,1,1] op_sel_hi:[1,1,1]
  s_lshl_b32 s64, s67, 7
  s_lshr_b32 s77, s3, 1
  s_mul_i32 s77, s77, 6
  s_add_u32 s77, s77, s3
  s_mul_i32 s77, s77, 14336
  s_add_u32 s77, s77, s64
  s_mul_i32 s75, s3, 50176
  s_add_u32 s75, s75, s64
  s_mov_b32 s57, 7168
  s_mul_i32 s65, s3, 7168
  s_lshl_b32 s64, s4, 11
  s_add_u32 s64, s64, 32768
  s_add_u32 s63, s71, 4096
  v_lshrrev_b32 v241, 2, v0
  v_lshlrev_b32 v241, 7, v241
  s_mov_b32 s68, 0
  s_waitcnt lgkmcnt(0)
L_sl:
  s_cmp_lg_u32 s56, 0
  s_cbranch_scc1 L_sl1
  buffer_load_dwordx4 v[40:43], v243, s[48:51], s70 offen sc1
  s_cmp_ge_u32 s59, 5
  s_cbranch_scc1 L_sl2
L_sl1:
  s_cmp_ge_u32 s59, 7
  s_cbranch_scc1 L_sl2
  s_add_u32 m0, s74, 0
  s_add_u32 s61, s73, 896
  buffer_load_dwordx4 v7, s[12:15], s61 offen  lds
  s_add_u32 m0, s74, 28672
  s_add_u32 s61, s73, 1792
  buffer_load_dwordx4 v7, s[12:15], s61 offen  lds
  s_add_u32 m0, s74, 57344
  s_add_u32 s61, s73, 0
  buffer_load_dwordx4 v7, s[12:15], s61 offen  lds
  s_add_u32 s73, s73, 172032
  s_add_u32 s74, s74, 4096
  s_add_u32 s59, s59, 1
  s_cmp_ge_u32 s74, 28672
  s_cselect_b32 s61, 28672, 0
  s_sub_u32 s74, s74, s61
  s_mul_i32 s61, s61, 42
  s_sub_u32 s73, s73, s61
  s_waitcnt vmcnt(3)
  s_branch L_sl3
L_sl2:
  s_add_u32 s68, s68, 1
  s_cmp_ge_u32 s68, 1048576
  s_cbranch_scc1 L_end
  s_waitcnt vmcnt(0)
L_sl3:
  s_cmp_lg_u32 s56, 0
  s_cbranch_scc1 L_sl4
  v_cmp_ne_u32 vcc, s6, v42
  s_nop 0
  s_cmp_lg_u64 vcc, 0
  s_cbranch_scc1 L_sl
  buffer_load_dwordx2 v[56:57], v241, s[48:51], s64 offen sc1
  ds_write_b64 v242, v[40:41]
  ds_read_b128 v[40:43], v244 offset:0
  ds_read_b128 v[44:47], v244 offset:256
  ds_read_b128 v[48:51], v244 offset:128
  ds_read_b128 v[52:55], v244 offset:384
  s_mov_b32 s56, 1
  s_waitcnt lgkmcnt(3)
  v_lshlrev_b32 v64, 16, v40
  v_and_b32 v65, 0xffff0000, v40
  v_lshlrev_b32 v66, 16, v41
  v_and_b32 v67, 0xffff0000, v41
  v_lshlrev_b32 v68, 16, v42
  v_and_b32 v69, 0xffff0000, v42
  v_lshlrev_b32 v70, 16, v43
  v_and_b32 v71, 0xffff0000, v43
  s_waitcnt lgkmcnt(2)
  v_lshlrev_b32 v72, 16, v44
  v_and_b32 v73, 0xffff0000, v44
  v_lshlrev_b32 v74, 16, v45
  v_and_b32 v75, 0xffff0000, v45
  v_lshlrev_b32 v76, 16, v46
  v_and_b32 v77, 0xffff0000, v46
  v_lshlrev_b32 v78, 16, v47
  v_and_b32 v79, 0xffff0000, v47
  v_pk_fma_f32 v[24:25], v[24:25], v[72:73], v[64:65]
  v_pk_fma_f32 v[26:27], v[26:27], v[74:75], v[66:67]
  v_pk_fma_f32 v[28:29], v[28:29], v[76:77], v[68:69]
  v_pk_fma_f32 v[30:31], v[30:31], v[78:79], v[70:71]
  v_cvt_pk_bf16_f32 v16, v24, v25
  v_cvt_pk_bf16_f32 v17, v26, v27
  v_cvt_pk_bf16_f32 v18, v28, v29
  v_cvt_pk_bf16_f32 v19, v30, v31
  buffer_store_dwordx4 v[16:19], v10, s[44:47], s71 offen offset:0
  v_pk_fma_f32 v[136:137], v[136:137], v[72:73], v[64:65]
  v_pk_fma_f32 v[138:139], v[138:139], v[74:75], v[66:67]
  v_pk_fma_f32 v[140:141], v[140:141], v[76:77], v[68:69]
  v_pk_fma_f32 v[142:143], v[142:143], v[78:79], v[70:71]
  v_cvt_pk_bf16_f32 v128, v136, v137
  v_cvt_pk_bf16_f32 v129, v138, v139
  v_cvt_pk_bf16_f32 v130, v140, v141
  v_cvt_pk_bf16_f32 v131, v142, v143
  buffer_store_dwordx4 v[128:131], v10, s[44:47], s71 offen offset:128
  s_waitcnt lgkmcnt(1)
  v_lshlrev_b32 v64, 16, v48
  v_and_b32 v65, 0xffff0000, v48
  v_lshlrev_b32 v66, 16, v49
  v_and_b32 v67, 0xffff0000, v49
  v_lshlrev_b32 v68, 16, v50
  v_and_b32 v69, 0xffff0000, v50
  v_lshlrev_b32 v70, 16, v51
  v_and_b32 v71, 0xffff0000, v51
  s_waitcnt lgkmcnt(0)
  v_lshlrev_b32 v72, 16, v52
  v_and_b32 v73, 0xffff0000, v52
  v_lshlrev_b32 v74, 16, v53
  v_and_b32 v75, 0xffff0000, v53
  v_lshlrev_b32 v76, 16, v54
  v_and_b32 v77, 0xffff0000, v54
  v_lshlrev_b32 v78, 16, v55
  v_and_b32 v79, 0xffff0000, v55
  s_lshr_b64 exec, -1, 16
  v_pk_fma_f32 v[32:33], v[32:33], v[72:73], v[64:65]
  v_pk_fma_f32 v[34:35], v[34:35], v[74:75], v[66:67]
  v_pk_fma_f32 v[36:37], v[36:37], v[76:77], v[68:69]
  v_pk_fma_f32 v[38:39], v[38:39], v[78:79], v[70:71]
  v_cvt_pk_bf16_f32 v20, v32, v33
  v_cvt_pk_bf16_f32 v21, v34, v35
  v_cvt_pk_bf16_f32 v22, v36, v37
  v_cvt_pk_bf16_f32 v23, v38, v39
  buffer_store_dwordx4 v[20:23], v10, s[44:47], s63 offen offset:0
  v_pk_fma_f32 v[144:145], v[144:145], v[72:73], v[64:65]
  v_pk_fma_f32 v[146:147], v[146:147], v[74:75], v[66:67]
  v_pk_fma_f32 v[148:149], v[148:149], v[76:77], v[68:69]
  v_pk_fma_f32 v[150:151], v[150:151], v[78:79], v[70:71]
  v_cvt_pk_bf16_f32 v132, v144, v145
  v_cvt_pk_bf16_f32 v133, v146, v147
  v_cvt_pk_bf16_f32 v134, v148, v149
  v_cvt_pk_bf16_f32 v135, v150, v151
  buffer_store_dwordx4 v[132:135], v10, s[44:47], s63 offen offset:128
  s_mov_b64 exec, -1
  s_waitcnt vmcnt(0)
L_sl4:
  s_cmp_eq_u32 s56, 2
  s_cbranch_scc1 L_sl5
  v_cmp_ne_u32 vcc, s6, v57
  s_nop 0
  s_cmp_lg_u64 vcc, 0
  s_cbranch_scc1 L_chk_2
L_chk_2r:
  v_cmp_ne_u32 vcc, s7, v56
  s_nop 0
  s_cmp_lg_u64 vcc, 0
  s_cselect_b32 s7, -1, 0
  s_xor_b32 s76, s6, s7
  s_cmp_lg_u32 s7, 0
  s_mov_b64 exec, 1
  s_cbranch_scc1 L_rel_3
  buffer_store_dword v3, off, s[48:51], s72 offset:0
L_rel_3r:
  s_mov_b64 exec, -1
  s_mov_b32 s56, 2
L_sl5:
  s_cmp_ge_u32 s59, 7
  s_cbranch_scc1 L_sl6
  s_add_u32 m0, s74, 0
  s_add_u32 s61, s73, 896
  buffer_load_dwordx4 v7, s[12:15], s61 offen  lds
  s_add_u32 m0, s74, 28672
  s_add_u32 s61, s73, 1792
  buffer_load_dwordx4 v7, s[12:15], s61 offen  lds
  s_add_u32 m0, s74, 57344
  s_add_u32 s61, s73, 0
  buffer_load_dwordx4 v7, s[12:15], s61 offen  lds
  s_add_u32 s73, s73, 172032
  s_add_u32 s74, s74, 4096
  s_add_u32 s59, s59, 1
  s_cmp_ge_u32 s74, 28672
  s_cselect_b32 s61, 28672, 0
  s_sub_u32 s74, s74, s61
  s_mul_i32 s61, s61, 42
  s_sub_u32 s73, s73, s61
  s_branch L_sl5
L_sl6:
  s_mov_b32 s58, 42
  s_branch L_join
L_nonh:
  s_lshl_b32 s64, s67, 7
  s_lshr_b32 s77, s3, 1
  s_mul_i32 s77, s77, 6
  s_add_u32 s77, s77, s3
  s_mul_i32 s77, s77, 14336
  s_add_u32 s77, s77, s64
  s_mul_i32 s75, s3, 50176
  s_add_u32 s75, s75, s64
  s_mov_b32 s57, 7168
  s_mul_i32 s65, s3, 7168
  s_lshl_b32 s64, s4, 11
  s_add_u32 s64, s64, 32768
  s_add_u32 s63, s71, 4096
  v_lshrrev_b32 v241, 2, v0
  v_lshlrev_b32 v241, 7, v241
  s_lshl1_add_u32 s58, s4, s5
  s_cmp_ge_u32 s5, 14
  s_cselect_b32 s58, s58, 42
  s_mul_i32 s70, s3, 43008
  s_lshl_b32 s62, s58, 7
  s_add_u32 s70, s70, s62
  s_lshl_b32 s71, s3, 10
  v_lshrrev_b32 v12, 3, v0
  v_mul_u32_u24 v12, 4480, v12
  v_add_u32 v12, v1, v12
  s_lshl_b32 s62, s3, 8
  s_load_dword s68, s[44:45], 0
  s_load_dword s68, s[20:21], 0
  s_load_dword s68, s[16:17], 0
  s_load_dword s68, s[28:29], 0
  s_load_dword s68, s[32:33], 0
  s_load_dword s68, s[24:25], 0
  s_cmp_ge_u32 s58, 42
  s_cbranch_scc1 L_nz0
  buffer_load_dword v60, v243, s[36:39], s62 offen
  s_add_u32 m0, s71, 86016
  s_add_u32 s61, s70, 0
  buffer_load_dwordx4 v12, s[40:43], s61 offen  lds
  s_add_u32 m0, s71, 90112
  s_add_u32 s61, s70, 172032
  buffer_load_dwordx4 v12, s[40:43], s61 offen  lds
  s_add_u32 m0, s71, 94208
  s_add_u32 s61, s70, 344064
  buffer_load_dwordx4 v12, s[40:43], s61 offen  lds
  s_add_u32 m0, s71, 98304
  s_add_u32 s61, s70, 516096
  buffer_load_dwordx4 v12, s[40:43], s61 offen  lds
  s_add_u32 m0, s71, 102400
  s_add_u32 s61, s70, 688128
  buffer_load_dwordx4 v12, s[40:43], s61 offen  lds
  s_add_u32 m0, s71, 106496
  s_add_u32 s61, s70, 860160
  buffer_load_dwordx4 v12, s[40:43], s61 offen  lds
  s_add_u32 m0, s71, 110592
  s_add_u32 s61, s70, 1032192
  buffer_load_dwordx4 v12, s[40:43], s61 offen  lds
L_nz0:
  s_add_u32 m0, s74, 0
  s_add_u32 s61, s73, 896
  buffer_load_dwordx4 v7, s[12:15], s61 offen  lds
  s_add_u32 m0, s74, 28672
  s_add_u32 s61, s73, 1792
  buffer_load_dwordx4 v7, s[12:15], s61 offen  lds
  s_add_u32 m0, s74, 57344
  s_add_u32 s61, s73, 0
  buffer_load_dwordx4 v7, s[12:15], s61 offen  lds
  s_add_u32 s73, s73, 172032
  s_add_u32 s74, s74, 4096
  s_add_u32 s59, s59, 1
  s_cmp_ge_u32 s74, 28672
  s_cselect_b32 s61, 28672, 0
  s_sub_u32 s74, s74, s61
  s_mul_i32 s61, s61, 42
  s_sub_u32 s73, s73, s61
  s_cmp_ge_u32 s58, 42
  s_cbranch_scc1 L_nz1
  s_add_u32 m0, s71, 114688
  s_add_u32 s61, s70, 1204224
  buffer_load_dwordx4 v12, s[40:43], s61 offen  lds
  s_add_u32 m0, s71, 118784
  s_add_u32 s61, s70, 1376256
  buffer_load_dwordx4 v12, s[40:43], s61 offen  lds
  s_add_u32 m0, s71, 122880
  s_add_u32 s61, s70, 1548288
  buffer_load_dwordx4 v12, s[40:43], s61 offen  lds
  s_add_u32 m0, s71, 126976
  s_add_u32 s61, s70, 1720320
  buffer_load_dwordx4 v12, s[40:43], s61 offen  lds
  s_add_u32 m0, s71, 131072
  s_add_u32 s61, s70, 1892352
  buffer_load_dwordx4 v12, s[40:43], s61 offen  lds
  s_add_u32 m0, s71, 135168
  s_add_u32 s61, s70, 2064384
  buffer_load_dwordx4 v12, s[40:43], s61 offen  lds
  s_add_u32 m0, s71, 139264
  s_add_u32 s61, s70, 2236416
  buffer_load_dwordx4 v12, s[40:43], s61 offen  lds
L_nz1:
  s_add_u32 m0, s74, 0
  s_add_u32 s61, s73, 896
  buffer_load_dwordx4 v7, s[12:15], s61 offen  lds
  s_add_u32 m0, s74, 28672
  s_add_u32 s61, s73, 1792
  buffer_load_dwordx4 v7, s[12:15], s61 offen  lds
  s_add_u32 m0, s74, 57344
  s_add_u32 s61, s73, 0
  buffer_load_dwordx4 v7, s[12:15], s61 offen  lds
  s_add_u32 s73, s73, 172032
  s_add_u32 s74, s74, 4096
  s_add_u32 s59, s59, 1
  s_cmp_ge_u32 s74, 28672
  s_cselect_b32 s61, 28672, 0
  s_sub_u32 s74, s74, s61
  s_mul_i32 s61, s61, 42
  s_sub_u32 s73, s73, s61
  s_cmp_ge_u32 s58, 42
  s_cbranch_scc1 L_nz2
L_nz2:
  s_add_u32 m0, s74, 0
  s_add_u32 s61, s73, 896
  buffer_load_dwordx4 v7, s[12:15], s61 offen  lds
  s_add_u32 m0, s74, 28672
  s_add_u32 s61, s73, 1792
  buffer_load_dwordx4 v7, s[12:15], s61 offen  lds
  s_add_u32 m0, s74, 57344
  s_add_u32 s61, s73, 0
  buffer_load_dwordx4 v7, s[12:15], s61 offen  lds
  s_add_u32 s73, s73, 172032
  s_add_u32 s74, s74, 4096
  s_add_u32 s59, s59, 1
  s_cmp_ge_u32 s74, 28672
  s_cselect_b32 s61, 28672, 0
  s_sub_u32 s74, s74, s61
  s_mul_i32 s61, s61, 42
  s_sub_u32 s73, s73, s61
  s_cmp_ge_u32 s58, 42
  s_cbranch_scc1 L_nz3
L_nz3:
  s_add_u32 m0, s74, 0
  s_add_u32 s61, s73, 896
  buffer_load_dwordx4 v7, s[12:15], s61 offen  lds
  s_add_u32 m0, s74, 28672
  s_add_u32 s61, s73, 1792
  buffer_load_dwordx4 v7, s[12:15], s61 offen  lds
  s_add_u32 m0, s74, 57344
  s_add_u32 s61, s73, 0
  buffer_load_dwordx4 v7, s[12:15], s61 offen  lds
  s_add_u32 s73, s73, 172032
  s_add_u32 s74, s74, 4096
  s_add_u32 s59, s59, 1
  s_cmp_ge_u32 s74, 28672
  s_cselect_b32 s61, 28672, 0
  s_sub_u32 s74, s74, s61
  s_mul_i32 s61, s61, 42
  s_sub_u32 s73, s73, s61
  s_cmp_ge_u32 s58, 42
  s_cbranch_scc1 L_nz4
  s_add_u32 s62, s62, 160256
  v_add_u32 v13, s62, v243
  s_waitcnt vmcnt(12)
  v_lshlrev_b32 v61, 16, v60
  v_and_b32 v62, 0xffff0000, v60
  v_mul_f32 v63, 0xbfb8aa3b, v61
  v_mul_f32 v60, 0xbfb8aa3b, v62
  v_exp_f32 v63, v63
  v_exp_f32 v60, v60
  v_add_f32 v63, 1.0, v63
  v_add_f32 v60, 1.0, v60
  v_rcp_f32 v63, v63
  v_rcp_f32 v60, v60
  v_mul_f32 v61, v61, v63
  v_mul_f32 v62, v62, v60
  v_cvt_pk_bf16_f32 v60, v61, v62
  ds_write_b32 v13, v60
  s_waitcnt lgkmcnt(0)
L_nz4:
  buffer_load_dwordx2 v[56:57], v241, s[48:51], s64 offen sc1
  s_add_u32 m0, s74, 0
  s_add_u32 s61, s73, 896
  buffer_load_dwordx4 v7, s[12:15], s61 offen  lds
  s_add_u32 m0, s74, 28672
  s_add_u32 s61, s73, 1792
  buffer_load_dwordx4 v7, s[12:15], s61 offen  lds
  s_add_u32 m0, s74, 57344
  s_add_u32 s61, s73, 0
  buffer_load_dwordx4 v7, s[12:15], s61 offen  lds
  s_add_u32 s73, s73, 172032
  s_add_u32 s74, s74, 4096
  s_add_u32 s59, s59, 1
  s_cmp_ge_u32 s74, 28672
  s_cselect_b32 s61, 28672, 0
  s_sub_u32 s74, s74, s61
  s_mul_i32 s61, s61, 42
  s_sub_u32 s73, s73, s61
  s_waitcnt lgkmcnt(0)
  s_waitcnt vmcnt(3)
  v_cmp_ne_u32 vcc, s6, v57
  s_nop 0
  s_cmp_lg_u64 vcc, 0
  s_cbranch_scc1 L_chk_4
L_chk_4r:
  v_cmp_ne_u32 vcc, s7, v56
  s_nop 0
  s_cmp_lg_u64 vcc, 0
  s_cselect_b32 s7, -1, 0
  s_xor_b32 s76, s6, s7
  s_branch L_pg_5
  .p2align 12
L_pg_5:
L_join:
  v_lshrrev_b32 v240, 3, v0
  v_lshlrev_b32 v240, 2, v240
  s_lshl_b32 s70, s3, 6
  s_add_u32 s70, s70, s60
  s_add_u32 s70, s70, 522752
  s_lshl2_add_u32 s71, s4, s3
  s_mul_i32 s71, s71, 28672
  v_lshl_add_u32 v12, s3, 10, v2
  v_xor_b32 v13, 1024, v12
  v_xor_b32 v14, 2048, v12
  v_xor_b32 v15, 3072, v12
  s_lshl1_add_u32 s62, s4, s66
  s_lshl2_add_u32 s62, s62, s3
  s_mul_i32 s62, s62, 14336
  s_lshl_b32 s63, s67, 7
  s_add_u32 s62, s62, s63
  s_lshl_b32 s63, s3, 11
  s_cmp_ge_u32 s5, 14
  s_cbranch_scc1 L_noxr
  s_add_u32 m0, s63, 114688
  s_add_u32 s61, s62, 0
  buffer_load_dwordx4 v1, s[8:11], s61 offen  lds
  s_add_u32 m0, s63, 115712
  s_add_u32 s61, s62, 7168
  buffer_load_dwordx4 v1, s[8:11], s61 offen  lds
L_noxr:
  s_mov_b32 s68, 0
L_poll_6:
  buffer_load_dword v241, v240, s[48:51], s70 offen sc1
  s_add_u32 s68, s68, 1
  s_cmp_ge_u32 s68, 1048576
  s_cbranch_scc1 L_end
  s_waitcnt vmcnt(0)
  v_cmp_ne_u32 vcc, s6, v241
  s_nop 0
  s_cmp_lg_u64 vcc, 0
  s_cbranch_scc1 L_poll_6
  s_cmp_lg_u32 s7, 0
  s_cbranch_scc1 L_acq_7
L_acq_7r:
  buffer_load_dwordx4 v[96:99], v12, s[44:47], s71 offen sc1
  buffer_load_dwordx4 v[100:103], v13, s[44:47], s71 offen sc1
  s_barrier
  ds_read_b64_tr_b16 a[208:209], v8 offset:0
  ds_read_b64_tr_b16 a[210:211], v8 offset:256
  ds_read_b64_tr_b16 a[212:213], v8 offset:28672
  ds_read_b64_tr_b16 a[214:215], v8 offset:28928
  ds_read_b64_tr_b16 a[216:217], v8 offset:1024
  ds_read_b64_tr_b16 a[218:219], v8 offset:1280
  ds_read_b64_tr_b16 a[220:221], v8 offset:29696
  ds_read_b64_tr_b16 a[222:223], v8 offset:29952
  ds_read_b64_tr_b16 a[224:225], v8 offset:2048
  ds_read_b64_tr_b16 a[226:227], v8 offset:2304
  ds_read_b64_tr_b16 a[228:229], v8 offset:30720
  ds_read_b64_tr_b16 a[230:231], v8 offset:30976
  buffer_load_dwordx4 v[104:107], v14, s[44:47], s71 offen sc1
  buffer_load_dwordx4 v[108:111], v15, s[44:47], s71 offen sc1
  s_add_u32 s71, s71, 4096
  buffer_load_dwordx4 v[112:115], v12, s[44:47], s71 offen sc1
  buffer_load_dwordx4 v[116:119], v13, s[44:47], s71 offen sc1
  s_waitcnt lgkmcnt(8) vmcnt(5)
  v_mfma_f32_32x32x16_bf16 v[208:223], a[208:211], v[96:99], 0
  buffer_load_dwordx4 v[120:123], v14, s[44:47], s71 offen sc1
  ds_read_b64_tr_b16 a[232:233], v8 offset:3072
  ds_read_b64_tr_b16 a[234:235], v8 offset:3328
  v_mfma_f32_32x32x16_bf16 v[224:239], v[96:99], a[212:215], 0
  ds_read_b64_tr_b16 a[236:237], v8 offset:31744
  ds_read_b64_tr_b16 a[238:239], v8 offset:32000
  v_cmp_lt_u32 s[62:63], 31, v0
  s_waitcnt lgkmcnt(8) vmcnt(5)
  v_mfma_f32_32x32x16_bf16 v[208:223], a[216:219], v[100:103], v[208:223]
  buffer_load_dwordx4 v[124:127], v15, s[44:47], s71 offen sc1
  ds_read_b64_tr_b16 a[240:241], v8 offset:4096
  ds_read_b64_tr_b16 a[242:243], v8 offset:4352
  v_mfma_f32_32x32x16_bf16 v[224:239], v[100:103], a[220:223], v[224:239]
  ds_read_b64_tr_b16 a[244:245], v8 offset:32768
  ds_read_b64_tr_b16 a[246:247], v8 offset:33024
  v_and_b32 v240, 31, v0
  s_waitcnt lgkmcnt(8) vmcnt(5)
  v_mfma_f32_32x32x16_bf16 v[208:223], a[224:227], v[104:107], v[208:223]
  s_add_u32 s71, s71, 4096
  buffer_load_dwordx4 v[128:131], v12, s[44:47], s71 offen sc1
  ds_read_b64_tr_b16 a[248:249], v8 offset:5120
  ds_read_b64_tr_b16 a[250:251], v8 offset:5376
  v_mfma_f32_32x32x16_bf16 v[224:239], v[104:107], a[228:231], v[224:239]
  ds_read_b64_tr_b16 a[252:253], v8 offset:33792
  ds_read_b64_tr_b16 a[254:255], v8 offset:34048
  v_cmp_eq_u32 vcc, 28, v240
  s_and_b32 s68, s3, 1
  s_waitcnt lgkmcnt(8) vmcnt(5)
  v_mfma_f32_32x32x16_bf16 v[208:223], a[232:235], v[108:111], v[208:223]
  buffer_load_dwordx4 v[132:135], v13, s[44:47], s71 offen sc1
  ds_read_b64_tr_b16 a[208:209], v8 offset:6144
  ds_read_b64_tr_b16 a[210:211], v8 offset:6400
  v_mfma_f32_32x32x16_bf16 v[224:239], v[108:111], a[236:239], v[224:239]
  ds_read_b64_tr_b16 a[212:213], v8 offset:34816
  ds_read_b64_tr_b16 a[214:215], v8 offset:35072
  v_mov_b32 v241, 0x3f803f80
  s_lshl_b32 s68, s68, 12
  s_waitcnt lgkmcnt(8) vmcnt(5)
  v_mfma_f32_32x32x16_bf16 v[208:223], a[240:243], v[112:115], v[208:223]
  buffer_load_dwordx4 v[136:139], v14, s[44:47], s71 offen sc1
  ds_read_b64_tr_b16 a[216:217], v8 offset:7168
  ds_read_b64_tr_b16 a[218:219], v8 offset:7424
  v_mfma_f32_32x32x16_bf16 v[224:239], v[112:115], a[244:247], v[224:239]
  ds_read_b64_tr_b16 a[220:221], v8 offset:35840
  ds_read_b64_tr_b16 a[222:223], v8 offset:36096
  v_mov_b32 v242, 0x3f800000
  s_add_u32 s68, s68, 114688
  s_waitcnt lgkmcnt(8) vmcnt(5)
  v_mfma_f32_32x32x16_bf16 v[208:223], a[248:251], v[116:119], v[208:223]
  buffer_load_dwordx4 v[140:143], v15, s[44:47], s71 offen sc1
  ds_read_b64_tr_b16 a[224:225], v8 offset:8192
  ds_read_b64_tr_b16 a[226:227], v8 offset:8448
  v_mfma_f32_32x32x16_bf16 v[224:239], v[116:119], a[252:255], v[224:239]
  ds_read_b64_tr_b16 a[228:229], v8 offset:36864
  ds_read_b64_tr_b16 a[230:231], v8 offset:37120
  s_lshl2_add_u32 s64, s5, s3
  v_lshl_add_u32 v250, v240, 7, s68
  s_waitcnt lgkmcnt(8) vmcnt(5)
  v_mfma_f32_32x32x16_bf16 v[208:223], a[208:211], v[120:123], v[208:223]
  s_add_u32 s71, s71, 4096
  buffer_load_dwordx4 v[144:147], v12, s[44:47], s71 offen sc1
  ds_read_b64_tr_b16 a[232:233], v8 offset:9216
  ds_read_b64_tr_b16 a[234:235], v8 offset:9472
  v_mfma_f32_32x32x16_bf16 v[224:239], v[120:123], a[212:215], v[224:239]
  ds_read_b64_tr_b16 a[236:237], v8 offset:37888
  ds_read_b64_tr_b16 a[238:239], v8 offset:38144
  s_lshl_b32 s70, s64, 12
  v_bfe_u32 v251, v0, 1, 1
  s_waitcnt lgkmcnt(8) vmcnt(5)
  v_mfma_f32_32x32x16_bf16 v[208:223], a[216:219], v[124:127], v[208:223]
  buffer_load_dwordx4 v[148:151], v13, s[44:47], s71 offen sc1
  ds_read_b64_tr_b16 a[240:241], v8 offset:10240
  ds_read_b64_tr_b16 a[242:243], v8 offset:10496
  v_mfma_f32_32x32x16_bf16 v[224:239], v[124:127], a[220:223], v[224:239]
  ds_read_b64_tr_b16 a[244:245], v8 offset:38912
  ds_read_b64_tr_b16 a[246:247], v8 offset:39168
  s_add_u32 s70, s70, s60
  s_lshr_b32 s68, s3, 1
  s_waitcnt lgkmcnt(8) vmcnt(5)
  v_mfma_f32_32x32x16_bf16 v[208:223], a[224:227], v[128:131], v[208:223]
  buffer_load_dwordx4 v[152:155], v14, s[44:47], s71 offen sc1
  ds_read_b64_tr_b16 a[248:249], v8 offset:11264
  ds_read_b64_tr_b16 a[250:251], v8 offset:11520
  v_mfma_f32_32x32x16_bf16 v[224:239], v[128:131], a[228:231], v[224:239]
  ds_read_b64_tr_b16 a[252:253], v8 offset:39936
  ds_read_b64_tr_b16 a[254:255], v8 offset:40192
  s_lshl_b32 s72, s64, 7
  v_xor_b32 v251, s68, v251
  s_waitcnt lgkmcnt(8) vmcnt(5)
  v_mfma_f32_32x32x16_bf16 v[208:223], a[232:235], v[132:135], v[208:223]
  buffer_load_dwordx4 v[156:159], v15, s[44:47], s71 offen sc1
  ds_read_b64_tr_b16 a[208:209], v8 offset:12288
  ds_read_b64_tr_b16 a[210:211], v8 offset:12544
  v_mfma_f32_32x32x16_bf16 v[224:239], v[132:135], a[236:239], v[224:239]
  ds_read_b64_tr_b16 a[212:213], v8 offset:40960
  ds_read_b64_tr_b16 a[214:215], v8 offset:41216
  s_add_u32 s72, s72, s60
  v_lshl_add_u32 v250, v251, 6, v250
  s_waitcnt lgkmcnt(8) vmcnt(5)
  v_mfma_f32_32x32x16_bf16 v[208:223], a[240:243], v[136:139], v[208:223]
  s_add_u32 s71, s71, 4096
  buffer_load_dwordx4 v[160:163], v12, s[44:47], s71 offen sc1
  ds_read_b64_tr_b16 a[216:217], v8 offset:13312
  ds_read_b64_tr_b16 a[218:219], v8 offset:13568
  v_mfma_f32_32x32x16_bf16 v[224:239], v[136:139], a[244:247], v[224:239]
  ds_read_b64_tr_b16 a[220:221], v8 offset:41984
  ds_read_b64_tr_b16 a[222:223], v8 offset:42240
  s_add_u32 s72, s72, 983040
  v_lshrrev_b32 v251, 5, v0
  s_waitcnt lgkmcnt(8) vmcnt(5)
  v_mfma_f32_32x32x16_bf16 v[208:223], a[248:251], v[140:143], v[208:223]
  buffer_load_dwordx4 v[164:167], v13, s[44:47], s71 offen sc1
  ds_read_b64_tr_b16 a[224:225], v8 offset:14336
  ds_read_b64_tr_b16 a[226:227], v8 offset:14592
  v_mfma_f32_32x32x16_bf16 v[224:239], v[140:143], a[252:255], v[224:239]
  ds_read_b64_tr_b16 a[228:229], v8 offset:43008
  ds_read_b64_tr_b16 a[230:231], v8 offset:43264
  s_lshl_b32 s64, s3, 12
  v_lshl_add_u32 v250, v251, 3, v250
  s_waitcnt lgkmcnt(8) vmcnt(5)
  v_mfma_f32_32x32x16_bf16 v[208:223], a[208:211], v[144:147], v[208:223]
  buffer_load_dwordx4 v[168:171], v14, s[44:47], s71 offen sc1
  ds_read_b64_tr_b16 a[232:233], v8 offset:15360
  ds_read_b64_tr_b16 a[234:235], v8 offset:15616
  v_mfma_f32_32x32x16_bf16 v[224:239], v[144:147], a[212:215], v[224:239]
  ds_read_b64_tr_b16 a[236:237], v8 offset:44032
  ds_read_b64_tr_b16 a[238:239], v8 offset:44288
  s_add_u32 s64, s64, 114688
  ds_read_b64 v[16:17], v250 offset:0
  s_waitcnt lgkmcnt(9) vmcnt(5)
  v_mfma_f32_32x32x16_bf16 v[208:223], a[216:219], v[148:151], v[208:223]
  buffer_load_dwordx4 v[172:175], v15, s[44:47], s71 offen sc1
  ds_read_b64_tr_b16 a[240:241], v8 offset:16384
  ds_read_b64_tr_b16 a[242:243], v8 offset:16640
  v_mfma_f32_32x32x16_bf16 v[224:239], v[148:151], a[220:223], v[224:239]
  ds_read_b64_tr_b16 a[244:245], v8 offset:45056
  ds_read_b64_tr_b16 a[246:247], v8 offset:45312
  v_add_u32 v6, s64, v2
  ds_read_b64 v[18:19], v250 offset:16
  s_waitcnt lgkmcnt(10) vmcnt(5)
  v_mfma_f32_32x32x16_bf16 v[208:223], a[224:227], v[152:155], v[208:223]
  s_add_u32 s71, s71, 4096
  buffer_load_dwordx4 v[176:179], v12, s[44:47], s71 offen sc1
  ds_read_b64_tr_b16 a[248:249], v8 offset:17408
  ds_read_b64_tr_b16 a[250:251], v8 offset:17664
  v_mfma_f32_32x32x16_bf16 v[224:239], v[152:155], a[228:231], v[224:239]
  ds_read_b64_tr_b16 a[252:253], v8 offset:46080
  ds_read_b64_tr_b16 a[254:255], v8 offset:46336
  v_mov_b32 v255, v1
  ds_read_b64 v[20:21], v250 offset:32
  s_waitcnt lgkmcnt(11) vmcnt(5)
  v_mfma_f32_32x32x16_bf16 v[208:223], a[232:235], v[156:159], v[208:223]
  buffer_load_dwordx4 v[180:183], v13, s[44:47], s71 offen sc1
  ds_read_b64_tr_b16 a[208:209], v8 offset:18432
  ds_read_b64_tr_b16 a[210:211], v8 offset:18688
  v_mfma_f32_32x32x16_bf16 v[224:239], v[156:159], a[236:239], v[224:239]
  ds_read_b64_tr_b16 a[212:213], v8 offset:47104
  ds_read_b64_tr_b16 a[214:215], v8 offset:47360
  s_add_u32 s69, s65, 28672
  ds_read_b64 v[22:23], v250 offset:48
  s_waitcnt lgkmcnt(11) vmcnt(5)
  v_mfma_f32_32x32x16_bf16 v[208:223], a[240:243], v[160:163], v[208:223]
  buffer_load_dwordx4 v[184:187], v14, s[44:47], s71 offen sc1
  ds_read_b64_tr_b16 a[216:217], v8 offset:19456
  ds_read_b64_tr_b16 a[218:219], v8 offset:19712
  v_mfma_f32_32x32x16_bf16 v[224:239], v[160:163], a[244:247], v[224:239]
  ds_read_b64_tr_b16 a[220:221], v8 offset:48128
  ds_read_b64_tr_b16 a[222:223], v8 offset:48384
  v_lshrrev_b32 v245, 5, v0
  s_waitcnt lgkmcnt(10) vmcnt(5)
  v_mfma_f32_32x32x16_bf16 v[208:223], a[248:251], v[164:167], v[208:223]
  buffer_load_dwordx4 v[188:191], v15, s[44:47], s71 offen sc1
  ds_read_b64_tr_b16 a[224:225], v8 offset:20480
  ds_read_b64_tr_b16 a[226:227], v8 offset:20736
  v_mfma_f32_32x32x16_bf16 v[224:239], v[164:167], a[252:255], v[224:239]
  ds_read_b64_tr_b16 a[228:229], v8 offset:49152
  ds_read_b64_tr_b16 a[230:231], v8 offset:49408
  v_lshlrev_b32 v245, 2, v245
  s_waitcnt lgkmcnt(9) vmcnt(5)
  v_mfma_f32_32x32x16_bf16 v[208:223], a[208:211], v[168:171], v[208:223]
  s_add_u32 s71, s71, 4096
  buffer_load_dwordx4 v[192:195], v12, s[44:47], s71 offen sc1
  ds_read_b64_tr_b16 a[232:233], v8 offset:21504
  ds_read_b64_tr_b16 a[234:235], v8 offset:21760
  v_mfma_f32_32x32x16_bf16 v[224:239], v[168:171], a[212:215], v[224:239]
  ds_read_b64_tr_b16 a[236:237], v8 offset:50176
  ds_read_b64_tr_b16 a[238:239], v8 offset:50432
  v_sub_u32 v244, v240, v245
  s_waitcnt lgkmcnt(8) vmcnt(5)
  v_mfma_f32_32x32x16_bf16 v[208:223], a[216:219], v[172:175], v[208:223]
  buffer_load_dwordx4 v[196:199], v13, s[44:47], s71 offen sc1
  ds_read_b64_tr_b16 a[240:241], v8 offset:22528
  ds_read_b64_tr_b16 a[242:243], v8 offset:22784
  v_mfma_f32_32x32x16_bf16 v[224:239], v[172:175], a[220:223], v[224:239]
  ds_read_b64_tr_b16 a[244:245], v8 offset:51200
  ds_read_b64_tr_b16 a[246:247], v8 offset:51456
  v_mov_b32 v245, 0xf149f2ca
  s_waitcnt lgkmcnt(8) vmcnt(5)
  v_mfma_f32_32x32x16_bf16 v[208:223], a[224:227], v[176:179], v[208:223]
  buffer_load_dwordx4 v[200:203], v14, s[44:47], s71 offen sc1
  ds_read_b64_tr_b16 a[248:249], v8 offset:23552
  ds_read_b64_tr_b16 a[250:251], v8 offset:23808
  v_mfma_f32_32x32x16_bf16 v[224:239], v[176:179], a[228:231], v[224:239]
  ds_read_b64_tr_b16 a[252:253], v8 offset:52224
  ds_read_b64_tr_b16 a[254:255], v8 offset:52480
  v_mov_b32 v246, 0
  s_waitcnt lgkmcnt(8) vmcnt(5)
  v_mfma_f32_32x32x16_bf16 v[208:223], a[232:235], v[180:183], v[208:223]
  buffer_load_dwordx4 v[204:207], v15, s[44:47], s71 offen sc1
  ds_read_b64_tr_b16 a[208:209], v8 offset:24576
  ds_read_b64_tr_b16 a[210:211], v8 offset:24832
  v_mfma_f32_32x32x16_bf16 v[224:239], v[180:183], a[236:239], v[224:239]
  ds_read_b64_tr_b16 a[212:213], v8 offset:53248
  ds_read_b64_tr_b16 a[214:215], v8 offset:53504
  s_waitcnt lgkmcnt(8) vmcnt(5)
  v_mfma_f32_32x32x16_bf16 v[208:223], a[240:243], v[184:187], v[208:223]
  ds_read_b64_tr_b16 a[216:217], v8 offset:25600
  ds_read_b64_tr_b16 a[218:219], v8 offset:25856
  v_mfma_f32_32x32x16_bf16 v[224:239], v[184:187], a[244:247], v[224:239]
  ds_read_b64_tr_b16 a[220:221], v8 offset:54272
  ds_read_b64_tr_b16 a[222:223], v8 offset:54528
  s_waitcnt lgkmcnt(8) vmcnt(4)
  v_mfma_f32_32x32x16_bf16 v[208:223], a[248:251], v[188:191], v[208:223]
  ds_read_b64_tr_b16 a[224:225], v8 offset:26624
  ds_read_b64_tr_b16 a[226:227], v8 offset:26880
  v_mfma_f32_32x32x16_bf16 v[224:239], v[188:191], a[252:255], v[224:239]
  ds_read_b64_tr_b16 a[228:229], v8 offset:55296
  ds_read_b64_tr_b16 a[230:231], v8 offset:55552
  s_waitcnt lgkmcnt(8) vmcnt(3)
  v_mfma_f32_32x32x16_bf16 v[208:223], a[208:211], v[192:195], v[208:223]
  ds_read_b64_tr_b16 a[232:233], v8 offset:27648
  ds_read_b64_tr_b16 a[234:235], v8 offset:27904
  v_mfma_f32_32x32x16_bf16 v[224:239], v[192:195], a[212:215], v[224:239]
  ds_read_b64_tr_b16 a[236:237], v8 offset:56320
  ds_read_b64_tr_b16 a[238:239], v8 offset:56576
  s_waitcnt lgkmcnt(8) vmcnt(2)
  v_mfma_f32_32x32x16_bf16 v[208:223], a[216:219], v[196:199], v[208:223]
  v_mfma_f32_32x32x16_bf16 v[224:239], v[196:199], a[220:223], v[224:239]
  s_waitcnt lgkmcnt(4) vmcnt(1)
  v_mfma_f32_32x32x16_bf16 v[208:223], a[224:227], v[200:203], v[208:223]
  v_mfma_f32_32x32x16_bf16 v[224:239], v[200:203], a[228:231], v[224:239]
  s_waitcnt lgkmcnt(0) vmcnt(0)
  v_mfma_f32_32x32x16_bf16 v[208:223], a[232:235], v[204:207], v[208:223]
  v_mfma_f32_32x32x16_bf16 v[224:239], v[204:207], a[236:239], v[224:239]
  s_nop 10
  v_cvt_pk_bf16_f32 v40, v208, v209
  v_cvt_pk_bf16_f32 v41, v210, v211
  v_cvt_pk_bf16_f32 v42, v212, v213
  v_cvt_pk_bf16_f32 v43, v214, v215
  buffer_store_dwordx4 v[40:43], v2, s[48:51], s70 offen sc1
  v_cvt_pk_bf16_f32 v44, v216, v217
  v_cvt_pk_bf16_f32 v45, v218, v219
  v_cvt_pk_bf16_f32 v46, v220, v221
  v_cvt_pk_bf16_f32 v47, v222, v223
  v_cndmask_b32 v46, v46, v242, s[62:63]
  v_cndmask_b32 v47, v47, v241, s[62:63]
  buffer_store_dwordx4 v[44:47], v2, s[48:51], s70 offen offset:1024 sc1
  v_cvt_pk_bf16_f32 v48, v224, v225
  v_cndmask_b32 v48, v48, v241, vcc
  v_cvt_pk_bf16_f32 v49, v226, v227
  v_cndmask_b32 v49, v49, v241, vcc
  v_cvt_pk_bf16_f32 v50, v228, v229
  v_cndmask_b32 v50, v50, v241, vcc
  v_cvt_pk_bf16_f32 v51, v230, v231
  v_cndmask_b32 v51, v51, v241, vcc
  buffer_store_dwordx4 v[48:51], v2, s[48:51], s70 offen offset:2048 sc1
  v_cvt_pk_bf16_f32 v52, v232, v233
  v_cndmask_b32 v52, v52, v241, vcc
  v_cvt_pk_bf16_f32 v53, v234, v235
  v_cndmask_b32 v53, v53, v241, vcc
  v_cvt_pk_bf16_f32 v54, v236, v237
  v_cndmask_b32 v54, v54, v241, vcc
  v_cvt_pk_bf16_f32 v55, v238, v239
  v_cndmask_b32 v55, v55, v241, vcc
  buffer_store_dwordx4 v[52:55], v2, s[48:51], s70 offen offset:3072 sc1
  s_barrier
  s_mov_b32 s36, 0
  s_mov_b32 s59, s5
  s_cmp_lt_u32 s5, 14
  s_cbranch_scc1 L_nohs
  s_mov_b32 s18, 0
  s_mov_b32 s36, 86016
  s_sub_u32 s65, s65, s36
  s_lshl4_add_u32 s64, s5, s4
  s_cmp_lt_u32 s64, 238
  s_cselect_b32 s22, 1605632, 0
  s_mov_b32 s59, s4
L_nohs:
  ds_read_b64_tr_b16 a[240:241], v9 offset:0
  ds_read_b64_tr_b16 a[242:243], v9 offset:256
  ds_read_b64_tr_b16 a[248:249], v9 offset:1024
  ds_read_b64_tr_b16 a[250:251], v9 offset:1280
  ds_read_b64_tr_b16 a[208:209], v9 offset:2048
  ds_read_b64_tr_b16 a[210:211], v9 offset:2304
  s_cmp_eq_u32 s3, 3
  s_cbranch_scc1 L_noown
  ds_write_b128 v6, v[40:43] offset:32768
  ds_write_b128 v6, v[44:47] offset:33792
  ds_write_b128 v6, v[48:51] offset:34816
  ds_write_b128 v6, v[52:55] offset:35840
L_noown:
  s_waitcnt lgkmcnt(4)
  v_mfma_f32_32x32x16_bf16 v[64:79], a[240:243], v[96:99], 0
  v_cmp_gt_i32 vcc, 0, v244
  ds_read_b64_tr_b16 a[216:217], v9 offset:3072
  ds_read_b64_tr_b16 a[218:219], v9 offset:3328
  v_cndmask_b32 v208, v246, v245, vcc
  v_lshrrev_b32 v248, 4, v0
  s_add_u32 m0, s65, 86016
  s_nop 0
  buffer_load_dwordx4 v255, s[16:19], s75 offen  lds
  s_waitcnt lgkmcnt(4)
  v_mfma_f32_32x32x16_bf16 v[64:79], a[248:251], v[100:103], v[64:79]
  v_cmp_gt_i32 vcc, 1, v244
  ds_read_b64_tr_b16 a[224:225], v9 offset:4096
  ds_read_b64_tr_b16 a[226:227], v9 offset:4352
  v_cndmask_b32 v209, v246, v245, vcc
  v_lshlrev_b32 v84, 7, v248
  s_waitcnt lgkmcnt(4)
  v_mfma_f32_32x32x16_bf16 v[64:79], a[208:211], v[104:107], v[64:79]
  v_cmp_gt_i32 vcc, 2, v244
  ds_read_b64_tr_b16 a[232:233], v9 offset:5120
  ds_read_b64_tr_b16 a[234:235], v9 offset:5376
  v_cndmask_b32 v210, v246, v245, vcc
  v_mul_u32_u24 v249, 3584, v248
  s_add_u32 m0, s65, 87040
  s_add_u32 s75, s75, s57
  buffer_load_dwordx4 v255, s[16:19], s75 offen  lds
  s_waitcnt lgkmcnt(4)
  v_mfma_f32_32x32x16_bf16 v[64:79], a[216:219], v[108:111], v[64:79]
  v_cmp_gt_i32 vcc, 3, v244
  ds_read_b64_tr_b16 a[240:241], v9 offset:6144
  ds_read_b64_tr_b16 a[242:243], v9 offset:6400
  v_cndmask_b32 v211, v246, v245, vcc
  v_lshlrev_b32 v248, 2, v248
  s_waitcnt lgkmcnt(4)
  v_mfma_f32_32x32x16_bf16 v[64:79], a[224:227], v[112:115], v[64:79]
  v_cmp_gt_i32 vcc, 8, v244
  ds_read_b64_tr_b16 a[248:249], v9 offset:7168
  ds_read_b64_tr_b16 a[250:251], v9 offset:7424
  v_cndmask_b32 v212, v246, v245, vcc
  v_and_b32 v80, 15, v0
  s_add_u32 m0, s65, 88064
  s_add_u32 s75, s75, s57
  buffer_load_dwordx4 v255, s[16:19], s75 offen  lds
  s_waitcnt lgkmcnt(4)
  v_mfma_f32_32x32x16_bf16 v[64:79], a[232:235], v[116:119], v[64:79]
  v_cmp_gt_i32 vcc, 9, v244
  ds_read_b64_tr_b16 a[208:209], v9 offset:8192
  ds_read_b64_tr_b16 a[210:211], v9 offset:8448
  v_cndmask_b32 v213, v246, v245, vcc
  v_xor_b32 v248, v248, v80
  s_waitcnt lgkmcnt(4)
  v_mfma_f32_32x32x16_bf16 v[64:79], a[240:243], v[120:123], v[64:79]
  v_cmp_gt_i32 vcc, 10, v244
  ds_read_b64_tr_b16 a[216:217], v9 offset:9216
  ds_read_b64_tr_b16 a[218:219], v9 offset:9472
  v_cndmask_b32 v214, v246, v245, vcc
  v_lshl_add_u32 v80, v248, 4, v249
  s_add_u32 m0, s65, 89088
  s_add_u32 s75, s75, s57
  buffer_load_dwordx4 v255, s[16:19], s75 offen  lds
  s_waitcnt lgkmcnt(4)
  v_mfma_f32_32x32x16_bf16 v[64:79], a[248:251], v[124:127], v[64:79]
  v_cmp_gt_i32 vcc, 11, v244
  ds_read_b64_tr_b16 a[224:225], v9 offset:10240
  ds_read_b64_tr_b16 a[226:227], v9 offset:10496
  v_cndmask_b32 v215, v246, v245, vcc
  v_add_u32 v81, 13312, v80
  s_waitcnt lgkmcnt(4)
  v_mfma_f32_32x32x16_bf16 v[64:79], a[208:211], v[128:131], v[64:79]
  v_cmp_gt_i32 vcc, 16, v244
  ds_read_b64_tr_b16 a[232:233], v9 offset:11264
  ds_read_b64_tr_b16 a[234:235], v9 offset:11520
  v_cndmask_b32 v216, v246, v245, vcc
  v_add_u32 v82, 26624, v80
  s_add_u32 m0, s65, 90112
  s_add_u32 s75, s75, s57
  buffer_load_dwordx4 v255, s[16:19], s75 offen  lds
  s_waitcnt lgkmcnt(4)
  v_mfma_f32_32x32x16_bf16 v[64:79], a[216:219], v[132:135], v[64:79]
  v_cmp_gt_i32 vcc, 17, v244
  ds_read_b64_tr_b16 a[240:241], v9 offset:12288
  ds_read_b64_tr_b16 a[242:243], v9 offset:12544
  v_cndmask_b32 v217, v246, v245, vcc
  v_add_u32 v83, 39936, v80
  s_waitcnt lgkmcnt(4)
  v_mfma_f32_32x32x16_bf16 v[64:79], a[224:227], v[136:139], v[64:79]
  v_cmp_gt_i32 vcc, 18, v244
  ds_read_b64_tr_b16 a[248:249], v9 offset:13312
  ds_read_b64_tr_b16 a[250:251], v9 offset:13568
  v_cndmask_b32 v218, v246, v245, vcc
  s_lshl_b32 s13, s3, 12
  s_add_u32 m0, s65, 91136
  s_add_u32 s75, s75, s57
  buffer_load_dwordx4 v255, s[16:19], s75 offen  lds
  s_waitcnt lgkmcnt(4)
  v_mfma_f32_32x32x16_bf16 v[64:79], a[232:235], v[140:143], v[64:79]
  v_cmp_gt_i32 vcc, 19, v244
  ds_read_b64_tr_b16 a[208:209], v9 offset:14336
  ds_read_b64_tr_b16 a[210:211], v9 offset:14592
  v_cndmask_b32 v219, v246, v245, vcc
  s_mul_i32 s69, s3, 57344
  s_waitcnt lgkmcnt(4)
  v_mfma_f32_32x32x16_bf16 v[64:79], a[240:243], v[144:147], v[64:79]
  v_cmp_gt_i32 vcc, 24, v244
  ds_read_b64_tr_b16 a[216:217], v9 offset:15360
  ds_read_b64_tr_b16 a[218:219], v9 offset:15616
  v_cndmask_b32 v220, v246, v245, vcc
  s_nop 0
  s_add_u32 m0, s65, 92160
  s_add_u32 s75, s75, s57
  buffer_load_dwordx4 v255, s[16:19], s75 offen  lds
  s_mov_b64 exec, 1
  s_waitcnt vmcnt(7)
  buffer_store_dword v3, off, s[48:51], s72 sc1
  s_mov_b64 exec, -1
  s_cmp_lt_u32 s58, 42
  s_cbranch_scc1 L_hs3
L_hs3r:
  s_waitcnt lgkmcnt(4)
  v_mfma_f32_32x32x16_bf16 v[64:79], a[248:251], v[148:151], v[64:79]
  v_cmp_gt_i32 vcc, 25, v244
  ds_read_b64_tr_b16 a[224:225], v9 offset:16384
  ds_read_b64_tr_b16 a[226:227], v9 offset:16640
  v_cndmask_b32 v221, v246, v245, vcc
  s_lshl_b32 s64, s59, 8
  s_waitcnt lgkmcnt(4)
  v_mfma_f32_32x32x16_bf16 v[64:79], a[208:211], v[152:155], v[64:79]
  v_cmp_gt_i32 vcc, 26, v244
  ds_read_b64_tr_b16 a[232:233], v9 offset:17408
  ds_read_b64_tr_b16 a[234:235], v9 offset:17664
  v_cndmask_b32 v222, v246, v245, vcc
  s_add_u32 s69, s69, s64
  s_add_u32 s65, s65, s36
  s_add_u32 m0, s65, 0
  s_mul_i32 s61, s57, 22
  s_add_u32 s75, s75, s61
  buffer_load_dwordx4 v255, s[16:19], s75 offen  lds
  s_waitcnt lgkmcnt(4)
  v_mfma_f32_32x32x16_bf16 v[64:79], a[216:219], v[156:159], v[64:79]
  v_cmp_gt_i32 vcc, 27, v244
  ds_read_b64_tr_b16 a[240:241], v9 offset:18432
  ds_read_b64_tr_b16 a[242:243], v9 offset:18688
  v_cndmask_b32 v223, v246, v245, vcc
  s_lshl_b32 s70, s3, 6
  s_waitcnt lgkmcnt(4)
  v_mfma_f32_32x32x16_bf16 v[64:79], a[224:227], v[160:163], v[64:79]
  ds_read_b64_tr_b16 a[248:249], v9 offset:19456
  ds_read_b64_tr_b16 a[250:251], v9 offset:19712
  s_add_u32 s70, s70, s64
  v_bfe_u32 v248, v0, 2, 2
  v_lshlrev_b32 v248, 7, v248
  s_add_u32 m0, s65, 1024
  s_add_u32 s75, s75, s57
  buffer_load_dwordx4 v255, s[16:19], s75 offen  lds
  s_waitcnt lgkmcnt(4)
  v_mfma_f32_32x32x16_bf16 v[64:79], a[232:235], v[164:167], v[64:79]
  ds_read_b64_tr_b16 a[208:209], v9 offset:20480
  ds_read_b64_tr_b16 a[210:211], v9 offset:20736
  v_and_b32 v249, 3, v0
  v_lshl_add_u32 v248, v249, 3, v248
  v_bfe_u32 v249, v0, 4, 1
  s_waitcnt lgkmcnt(4)
  v_mfma_f32_32x32x16_bf16 v[64:79], a[240:243], v[168:171], v[64:79]
  ds_read_b64_tr_b16 a[216:217], v9 offset:21504
  ds_read_b64_tr_b16 a[218:219], v9 offset:21760
  v_lshl_add_u32 v248, v249, 5, v248
  v_bfe_u32 v249, v0, 3, 1
  s_lshr_b32 s64, s3, 1
  s_add_u32 m0, s65, 2048
  s_add_u32 s75, s75, s57
  buffer_load_dwordx4 v255, s[16:19], s75 offen  lds
  s_waitcnt lgkmcnt(4)
  v_mfma_f32_32x32x16_bf16 v[64:79], a[248:251], v[172:175], v[64:79]
  ds_read_b64_tr_b16 a[224:225], v9 offset:22528
  ds_read_b64_tr_b16 a[226:227], v9 offset:22784
  v_xor_b32 v249, s64, v249
  v_lshl_add_u32 v12, v249, 6, v248
  v_lshrrev_b32 v249, 5, v0
  s_waitcnt lgkmcnt(4)
  v_mfma_f32_32x32x16_bf16 v[64:79], a[208:211], v[176:179], v[64:79]
  ds_read_b64_tr_b16 a[232:233], v9 offset:23552
  ds_read_b64_tr_b16 a[234:235], v9 offset:23808
  v_lshl_add_u32 v4, v249, 9, v12
  v_xor_b32 v5, 64, v4
  s_mul_i32 s68, s64, -86016
  s_add_u32 m0, s65, 3072
  s_add_u32 s75, s75, s57
  buffer_load_dwordx4 v255, s[16:19], s75 offen  lds
  s_waitcnt lgkmcnt(4)
  v_mfma_f32_32x32x16_bf16 v[64:79], a[216:219], v[180:183], v[64:79]
  ds_read_b64_tr_b16 a[240:241], v9 offset:24576
  ds_read_b64_tr_b16 a[242:243], v9 offset:24832
  s_add_u32 s68, s68, 86016
  v_add_u32 v12, s68, v12
  v_xor_b32 v13, 64, v12
  s_waitcnt lgkmcnt(4)
  v_mfma_f32_32x32x16_bf16 v[64:79], a[224:227], v[184:187], v[64:79]
  ds_read_b64_tr_b16 a[248:249], v9 offset:25600
  ds_read_b64_tr_b16 a[250:251], v9 offset:25856
  v_add_u32 v14, s68, v4
  v_add_u32 v15, s68, v5
  v_lshlrev_b32 v247, 4, v249
  s_add_u32 m0, s65, 4096
  s_add_u32 s75, s75, s57
  buffer_load_dwordx4 v255, s[16:19], s75 offen  lds
  s_waitcnt lgkmcnt(4)
  v_mfma_f32_32x32x16_bf16 v[64:79], a[232:235], v[188:191], v[64:79]
  ds_read_b64_tr_b16 a[208:209], v9 offset:26624
  ds_read_b64_tr_b16 a[210:211], v9 offset:26880
  v_mul_u32_u24 v86, 0xF149, v249
  v_lshlrev_b32 v88, 3, v249
  v_lshlrev_b32 v90, 7, v249
  s_waitcnt lgkmcnt(4)
  v_mfma_f32_32x32x16_bf16 v[64:79], a[240:243], v[192:195], v[64:79]
  ds_read_b64_tr_b16 a[216:217], v9 offset:27648
  ds_read_b64_tr_b16 a[218:219], v9 offset:27904
  s_lshl1_add_u32 s71, s67, s64
  s_lshl1_add_u32 s68, s4, s66
  s_and_b32 s11, s3, 1
  s_add_u32 m0, s65, 5120
  s_add_u32 s75, s75, s57
  buffer_load_dwordx4 v255, s[16:19], s75 offen  lds
  s_waitcnt lgkmcnt(4)
  v_mfma_f32_32x32x16_bf16 v[64:79], a[248:251], v[196:199], v[64:79]
  s_lshl1_add_u32 s68, s68, s11
  s_mul_i32 s68, s68, 28672
  s_lshl_b32 s14, s71, 11
  s_waitcnt lgkmcnt(2)
  v_mfma_f32_32x32x16_bf16 v[64:79], a[208:211], v[200:203], v[64:79]
  s_add_u32 s14, s14, s68
  s_lshl_b32 s71, s71, 6
  s_add_u32 s68, s68, s71
  s_add_u32 m0, s65, 6144
  s_add_u32 s75, s75, s57
  buffer_load_dwordx4 v255, s[16:19], s75 offen  lds
  s_waitcnt lgkmcnt(0)
  v_mfma_f32_32x32x16_bf16 v[64:79], a[216:219], v[204:207], v[64:79]
  v_mul_u32_u24 v248, 896, v240
  v_add3_u32 v8, v248, v247, s68
  v_lshlrev_b32 v87, 1, v240
  v_lshrrev_b32 v89, 2, v0
  v_lshlrev_b32 v89, 7, v89
  s_lshl4_add_u32 s68, s3, s5
  s_lshl_b32 s73, s68, 11
  s_add_u32 s73, s73, s60
  s_add_u32 s73, s73, 262144
  s_lshl2_add_u32 s74, s68, s60
  s_add_u32 s74, s74, 522240
  s_lshl_b32 s15, s68, 8
  s_add_u32 s15, s15, s60
  s_add_u32 s15, s15, 507904
  v_min_u32 v253, 880, v2
  s_add_u32 m0, s13, 32768
  s_add_u32 s12, s69, 458752
  buffer_load_dwordx4 v80, s[20:23], s12 offen offset:0  lds
  v_lshrrev_b32 v254, 6, v253
  v_lshlrev_b32 v254, 5, v254
  v_bfe_u32 v249, v253, 5, 1
  v_lshl_add_u32 v254, v249, 3, v254
  v_and_or_b32 v254, v253, 16, v254
  s_mul_i32 s68, s3, 896
  s_add_u32 s68, s68, 160256
  buffer_load_dwordx4 v81, s[20:23], s12 offen offset:1024  lds
  v_add_u32 v254, s68, v254
  s_lshl_b32 s56, s3, 11
  s_add_u32 s56, s56, 12288
  s_mov_b32 s52, s48
  s_mov_b32 s53, s49
  s_mov_b32 s55, 0x20000
  s_lshl_b32 s8, s11, 10
  buffer_load_dwordx4 v82, s[20:23], s12 offen offset:2048  lds
  s_lshl_b32 s9, s5, 14
  s_add_u32 s9, s9, s8
  s_lshl_b32 s68, s64, 14
  s_add_u32 s8, s8, s68
  s_add_u32 s8, s8, 114688
  v_add_u32 v85, s8, v2
  s_sub_u32 s64, 2, s64
  buffer_load_dwordx4 v83, s[20:23], s12 offen offset:3072  lds
  s_cmp_ge_u32 s4, s64
  s_cselect_b32 s54, 18874368, 0
  s_cselect_b32 s64, s64, 0
  s_cselect_b32 s11, 0, s11
  s_lshl_b32 s64, s64, 20
  s_sub_u32 s64, s60, s64
  s_add_u32 s9, s9, s64
  s_lshl_b32 s10, s5, 9
  s_add_u32 s10, s10, s64
  s_add_u32 s10, s10, 983040
  buffer_load_dword v252, v84, s[48:51], s10 offen sc1
  v_mov_b32 v242, 0x3e8b97f6
  v_pk_mul_f32 v[64:65], v[64:65], v[242:243] op_sel_hi:[1,0]
  v_pk_mul_f32 v[66:67], v[66:67], v[242:243] op_sel_hi:[1,0]
  v_pk_mul_f32 v[68:69], v[68:69], v[242:243] op_sel_hi:[1,0]
  v_pk_mul_f32 v[70:71], v[70:71], v[242:243] op_sel_hi:[1,0]
  v_pk_mul_f32 v[72:73], v[72:73], v[242:243] op_sel_hi:[1,0]
  v_pk_mul_f32 v[74:75], v[74:75], v[242:243] op_sel_hi:[1,0]
  v_pk_mul_f32 v[76:77], v[76:77], v[242:243] op_sel_hi:[1,0]
  v_pk_mul_f32 v[78:79], v[78:79], v[242:243] op_sel_hi:[1,0]
  v_cvt_pk_bf16_f32 v32, v64, v65
  v_cvt_pk_bf16_f32 v33, v66, v67
  v_cvt_pk_bf16_f32 v34, v68, v69
  v_cvt_pk_bf16_f32 v35, v70, v71
  v_cvt_pk_bf16_f32 v36, v72, v73
  v_cvt_pk_bf16_f32 v37, v74, v75
  v_cvt_pk_bf16_f32 v38, v76, v77
  v_cvt_pk_bf16_f32 v39, v78, v79
  v_mov_b32 v250, 0x3f80
  v_cndmask_b32 v38, v38, v250, s[62:63]
  v_cndmask_b32 v39, v39, v246, s[62:63]
  v_mfma_f32_32x32x16_bf16 v[128:143], v[40:43], v[32:35], v[208:223]
  s_nop 0
  v_mfma_f32_32x32x16_bf16 v[128:143], v[44:47], v[36:39], v[128:143]
  v_sub_f32 v192, v245, v208
  v_sub_f32 v193, v245, v209
  v_sub_f32 v194, v245, v210
  v_sub_f32 v195, v245, v211
  v_sub_f32 v196, v245, v212
  v_sub_f32 v197, v245, v213
  v_sub_f32 v198, v245, v214
  v_sub_f32 v199, v245, v215
  v_sub_f32 v200, v245, v216
  v_sub_f32 v201, v245, v217
  v_sub_f32 v202, v245, v218
  v_sub_f32 v203, v245, v219
  v_sub_f32 v204, v245, v220
  v_sub_f32 v205, v245, v221
  v_sub_f32 v206, v245, v222
  v_sub_f32 v207, v245, v223
  v_max_f32 v240, v128, v129
  v_max_f32 v241, v130, v131
  v_max3_f32 v240, v132, v133, v240
  v_max3_f32 v241, v134, v135, v241
  v_max3_f32 v240, v136, v137, v240
  v_max3_f32 v241, v138, v139, v241
  v_max3_f32 v240, v140, v141, v240
  v_max3_f32 v241, v142, v143, v241
  v_max_f32 v240, v240, v241
  v_mov_b32 v241, v240
  s_nop 1
  v_permlane32_swap_b32 v240, v241
  v_max_f32 v240, v240, v241
  v_xor_b32 v240, 0x80000000, v240
  v_and_b32 v241, 0xffff0000, v240
  v_sub_f32 v240, v240, v241
  v_and_b32 v242, 0xffff0000, v240
  v_sub_f32 v240, v240, v242
  v_or_b32 v241, 0x3f80, v241
  v_cvt_pk_bf16_f32 v240, v242, v240
  v_cndmask_b32 v38, v38, v241, s[62:63]
  v_cndmask_b32 v39, v39, v240, s[62:63]
  v_mfma_f32_32x32x16_bf16 v[128:143], v[40:43], v[32:35], v[208:223]
  s_nop 0
  v_mfma_f32_32x32x16_bf16 v[128:143], v[44:47], v[36:39], v[128:143]
  s_nop 11
  v_exp_f32 v128, v128
  v_exp_f32 v129, v129
  v_exp_f32 v130, v130
  v_exp_f32 v131, v131
  v_exp_f32 v132, v132
  v_exp_f32 v133, v133
  v_exp_f32 v134, v134
  v_exp_f32 v135, v135
  v_cvt_pk_bf16_f32 v160, v128, v129
  v_cvt_pk_bf16_f32 v161, v130, v131
  v_exp_f32 v136, v136
  v_exp_f32 v137, v137
  v_exp_f32 v138, v138
  v_exp_f32 v139, v139
  v_cvt_pk_bf16_f32 v162, v132, v133
  v_cvt_pk_bf16_f32 v163, v134, v135
  v_exp_f32 v140, v140
  v_exp_f32 v141, v141
  v_exp_f32 v142, v142
  v_exp_f32 v143, v143
  v_cvt_pk_bf16_f32 v164, v136, v137
  v_cvt_pk_bf16_f32 v165, v138, v139
  v_cvt_pk_bf16_f32 v166, v140, v141
  v_cvt_pk_bf16_f32 v167, v142, v143
  s_waitcnt lgkmcnt(0)
  s_waitcnt vmcnt(0)
  v_cmp_ne_u32 vcc, s6, v252
  s_nop 0
  s_cmp_lg_u64 vcc, 0
  s_cbranch_scc0 L_chk_8r
  L_chk_8:
  s_mov_b32 s68, 0
L_chk_8l:
  buffer_load_dword v252, v84, s[48:51], s10 offen sc1
  s_add_u32 s68, s68, 1
  s_cmp_ge_u32 s68, 1048576
  s_cbranch_scc1 L_end
  s_waitcnt vmcnt(0)
  v_cmp_ne_u32 vcc, s6, v252
  s_nop 1
  s_cmp_lg_u64 vcc, 0
  s_cbranch_scc1 L_chk_8l
L_chk_8r:
  s_add_u32 m0, s8, 12288
  s_add_u32 s61, s9, 12288
  buffer_load_dwordx4 v2, s[52:55], s61 offen sc1 lds
  s_add_u32 m0, s8, 8192
  s_add_u32 s61, s9, 8192
  buffer_load_dwordx4 v2, s[52:55], s61 offen sc1 lds
  s_add_u32 m0, s8, 4096
  s_add_u32 s61, s9, 4096
  buffer_load_dwordx4 v2, s[52:55], s61 offen sc1 lds
  s_add_u32 m0, s8, 0
  s_add_u32 s61, s9, 0
  buffer_load_dwordx4 v2, s[52:55], s61 offen sc1 lds
  s_add_u32 m0, s8, 14336
  s_add_u32 s61, s9, 14336
  buffer_load_dwordx4 v2, s[52:55], s61 offen sc1 lds
  s_add_u32 m0, s8, 10240
  s_add_u32 s61, s9, 10240
  buffer_load_dwordx4 v2, s[52:55], s61 offen sc1 lds
  s_add_u32 m0, s8, 6144
  s_add_u32 s61, s9, 6144
  buffer_load_dwordx4 v2, s[52:55], s61 offen sc1 lds
  s_add_u32 m0, s8, 2048
  s_add_u32 s61, s9, 2048
  buffer_load_dwordx4 v2, s[52:55], s61 offen sc1 lds
  s_barrier
  s_cmp_ge_u32 s5, 14
  s_cbranch_scc1 L_nohs3
  ds_read_b64_tr_b16 a[0:1], v14 offset:0
  ds_read_b64_tr_b16 a[2:3], v14 offset:1024
  ds_read_b64_tr_b16 a[4:5], v15 offset:0
  ds_read_b64_tr_b16 a[6:7], v15 offset:1024
  ds_read_b64_tr_b16 a[8:9], v14 offset:2048
  ds_read_b64_tr_b16 a[10:11], v12 offset:3072
  ds_read_b64_tr_b16 a[12:13], v15 offset:2048
  ds_read_b64_tr_b16 a[14:15], v13 offset:3072
  ds_read_b64_tr_b16 a[16:17], v14 offset:3584
  ds_read_b64_tr_b16 a[18:19], v14 offset:4608
  ds_read_b64_tr_b16 a[20:21], v15 offset:3584
  ds_read_b64_tr_b16 a[22:23], v15 offset:4608
  ds_read_b64_tr_b16 a[24:25], v14 offset:5632
  ds_read_b64_tr_b16 a[26:27], v12 offset:6656
  ds_read_b64_tr_b16 a[28:29], v15 offset:5632
  ds_read_b64_tr_b16 a[30:31], v13 offset:6656
  ds_read_b64_tr_b16 a[32:33], v14 offset:7168
  ds_read_b64_tr_b16 a[34:35], v14 offset:8192
  ds_read_b64_tr_b16 a[36:37], v15 offset:7168
  ds_read_b64_tr_b16 a[38:39], v15 offset:8192
  ds_read_b64_tr_b16 a[40:41], v14 offset:9216
  ds_read_b64_tr_b16 a[42:43], v12 offset:10240
  ds_read_b64_tr_b16 a[44:45], v15 offset:9216
  ds_read_b64_tr_b16 a[46:47], v13 offset:10240
  ds_read_b64_tr_b16 a[48:49], v14 offset:10752
  ds_read_b64_tr_b16 a[50:51], v14 offset:11776
  ds_read_b64_tr_b16 a[52:53], v15 offset:10752
  ds_read_b64_tr_b16 a[54:55], v15 offset:11776
  ds_read_b64_tr_b16 a[56:57], v14 offset:12800
  ds_read_b64_tr_b16 a[58:59], v12 offset:13824
  ds_read_b64_tr_b16 a[60:61], v15 offset:12800
  ds_read_b64_tr_b16 a[62:63], v13 offset:13824
  ds_read_b64_tr_b16 a[64:65], v14 offset:14336
  ds_read_b64_tr_b16 a[66:67], v14 offset:15360
  ds_read_b64_tr_b16 a[68:69], v15 offset:14336
  ds_read_b64_tr_b16 a[70:71], v15 offset:15360
  ds_read_b64_tr_b16 a[72:73], v14 offset:16384
  ds_read_b64_tr_b16 a[74:75], v12 offset:17408
  ds_read_b64_tr_b16 a[76:77], v15 offset:16384
  ds_read_b64_tr_b16 a[78:79], v13 offset:17408
  ds_read_b64_tr_b16 a[80:81], v14 offset:17920
  ds_read_b64_tr_b16 a[82:83], v14 offset:18944
  ds_read_b64_tr_b16 a[84:85], v15 offset:17920
  ds_read_b64_tr_b16 a[86:87], v15 offset:18944
  ds_read_b64_tr_b16 a[88:89], v14 offset:19968
  ds_read_b64_tr_b16 a[90:91], v12 offset:20992
  ds_read_b64_tr_b16 a[92:93], v15 offset:19968
  ds_read_b64_tr_b16 a[94:95], v13 offset:20992
  ds_read_b64_tr_b16 a[96:97], v14 offset:21504
  ds_read_b64_tr_b16 a[98:99], v14 offset:22528
  ds_read_b64_tr_b16 a[100:101], v15 offset:21504
  ds_read_b64_tr_b16 a[102:103], v15 offset:22528
  ds_read_b64_tr_b16 a[104:105], v14 offset:23552
  ds_read_b64_tr_b16 a[106:107], v12 offset:24576
  ds_read_b64_tr_b16 a[108:109], v15 offset:23552
  ds_read_b64_tr_b16 a[110:111], v13 offset:24576
  ds_read_b64_tr_b16 a[112:113], v14 offset:25088
  ds_read_b64_tr_b16 a[114:115], v14 offset:26112
  ds_read_b64_tr_b16 a[116:117], v15 offset:25088
  ds_read_b64_tr_b16 a[118:119], v15 offset:26112
  ds_read_b64_tr_b16 a[120:121], v14 offset:27136
  ds_read_b64_tr_b16 a[122:123], v12 offset:28160
  ds_read_b64_tr_b16 a[124:125], v15 offset:27136
  ds_read_b64_tr_b16 a[126:127], v13 offset:28160
L_nohs3:
  s_waitcnt vmcnt(4)
  s_cmp_eq_u32 s11, 0
  s_cbranch_scc1 L_nofix
  ds_write_b32 v85, v86 offset:8
  ds_write_b32 v85, v86 offset:4104
  ds_write_b32 v85, v86 offset:8200
  ds_write_b32 v85, v86 offset:12296
L_nofix:
  s_waitcnt lgkmcnt(0)
  s_barrier
  ds_read_b128 v[104:107], v6 offset:28672
  ds_read_b128 v[108:111], v6 offset:29696
  ds_read_b128 v[112:115], v6 offset:24576
  ds_read_b128 v[116:119], v6 offset:25600
  ds_read_b128 v[96:99], v6 offset:20480
  ds_read_b128 v[100:103], v6 offset:21504
  v_mfma_f32_32x32x16_bf16 v[176:191], v[48:51], v[160:163], 0
  v_mfma_f32_32x32x16_bf16 v[176:191], v[52:55], v[164:167], v[176:191]
  s_waitcnt lgkmcnt(5)
  v_mfma_f32_32x32x16_bf16 v[144:159], v[104:107], v[32:35], 0
  s_waitcnt lgkmcnt(4)
  v_mfma_f32_32x32x16_bf16 v[144:159], v[108:111], v[36:39], v[144:159]
  s_waitcnt vmcnt(0)
  s_barrier
  ds_read_b128 v[232:235], v6 offset:30720
  ds_read_b128 v[236:239], v6 offset:31744
  buffer_load_dword v250, v89, s[48:51], s73 offen sc1
  v_lshlrev_b32 v251, 7, v0
  s_lshl2_add_u32 s61, s2, s3
  s_mul_i32 s61, s61, 392
  s_lshl_b32 s61, s61, 2
  s_mov_b64 exec, 0x1fff
  buffer_load_dword v250, v251, s[28:31], s61 offen
  s_mov_b64 exec, -1
  buffer_load_dword v250, v89, s[44:47], s14 offen sc1
  buffer_load_dword v250, v90, s[48:51], s15 offen sc1
  buffer_load_dwordx2 v[24:25], v88, s[32:35], s71 offen offset:0
  buffer_load_dwordx2 v[26:27], v88, s[32:35], s71 offen offset:16
  buffer_load_dwordx2 v[28:29], v88, s[32:35], s71 offen offset:32
  buffer_load_dwordx2 v[30:31], v88, s[32:35], s71 offen offset:48
  buffer_load_ushort v9, v87, s[24:27], s70 offen
  s_waitcnt lgkmcnt(5)
  v_mfma_f32_32x32x16_bf16 v[128:143], v[112:115], v[32:35], 0
  v_exp_f32 v144, v144
  v_exp_f32 v145, v145
  v_exp_f32 v146, v146
  v_exp_f32 v147, v147
  s_add_u32 m0, s13, 0
  s_add_u32 s12, s69, 0
  buffer_load_dwordx4 v80, s[20:23], s12 offen offset:0  lds
  s_waitcnt lgkmcnt(4)
  v_mfma_f32_32x32x16_bf16 v[128:143], v[116:119], v[36:39], v[128:143]
  ds_read_b128 v[104:107], v6 offset:16384
  ds_read_b128 v[108:111], v6 offset:17408
  v_exp_f32 v148, v148
  v_exp_f32 v149, v149
  v_exp_f32 v150, v150
  v_exp_f32 v151, v151
  v_cvt_pk_bf16_f32 v168, v144, v145
  v_cvt_pk_bf16_f32 v169, v146, v147
  buffer_load_dwordx4 v81, s[20:23], s12 offen offset:1024  lds
  v_exp_f32 v152, v152
  v_exp_f32 v153, v153
  v_exp_f32 v154, v154
  v_exp_f32 v155, v155
  v_cvt_pk_bf16_f32 v170, v148, v149
  v_cvt_pk_bf16_f32 v171, v150, v151
  buffer_load_dwordx4 v82, s[20:23], s12 offen offset:2048  lds
  ds_read_b128 v[224:227], v6 offset:26624
  ds_read_b128 v[228:231], v6 offset:27648
  v_exp_f32 v156, v156
  v_exp_f32 v157, v157
  v_exp_f32 v158, v158
  v_exp_f32 v159, v159
  v_cvt_pk_bf16_f32 v172, v152, v153
  v_cvt_pk_bf16_f32 v173, v154, v155
  v_cvt_pk_bf16_f32 v174, v156, v157
  v_cvt_pk_bf16_f32 v175, v158, v159
  buffer_load_dwordx4 v[56:59], v253, s[48:51], s56 offen offset:0 sc1
  buffer_load_dwordx4 v[60:63], v253, s[48:51], s56 offen offset:896 sc1
  s_waitcnt lgkmcnt(7)
  v_mfma_f32_32x32x16_bf16 v[144:159], v[96:99], v[32:35], 0
  v_exp_f32 v128, v128
  v_exp_f32 v129, v129
  v_exp_f32 v130, v130
  v_exp_f32 v131, v131
  s_waitcnt lgkmcnt(6)
  v_mfma_f32_32x32x16_bf16 v[144:159], v[100:103], v[36:39], v[144:159]
  ds_read_b128 v[112:115], v6 offset:12288
  ds_read_b128 v[116:119], v6 offset:13312
  v_exp_f32 v132, v132
  v_exp_f32 v133, v133
  v_exp_f32 v134, v134
  v_exp_f32 v135, v135
  v_cvt_pk_bf16_f32 v160, v128, v129
  v_cvt_pk_bf16_f32 v161, v130, v131
  buffer_load_dwordx4 v83, s[20:23], s12 offen offset:3072  lds
  s_waitcnt lgkmcnt(7)
  v_mfma_f32_32x32x16_bf16 v[176:191], v[232:235], v[168:171], v[176:191]
  v_exp_f32 v136, v136
  v_exp_f32 v137, v137
  v_exp_f32 v138, v138
  v_exp_f32 v139, v139
  v_cvt_pk_bf16_f32 v162, v132, v133
  v_cvt_pk_bf16_f32 v163, v134, v135
  s_add_u32 m0, s13, 16384
  s_add_u32 s12, s69, 229376
  buffer_load_dwordx4 v80, s[20:23], s12 offen offset:0  lds
  s_waitcnt lgkmcnt(6)
  v_mfma_f32_32x32x16_bf16 v[176:191], v[236:239], v[172:175], v[176:191]
  ds_read_b128 v[232:235], v6 offset:22528
  ds_read_b128 v[236:239], v6 offset:23552
  v_exp_f32 v140, v140
  v_exp_f32 v141, v141
  v_exp_f32 v142, v142
  v_exp_f32 v143, v143
  v_cvt_pk_bf16_f32 v164, v136, v137
  v_cvt_pk_bf16_f32 v165, v138, v139
  v_cvt_pk_bf16_f32 v166, v140, v141
  v_cvt_pk_bf16_f32 v167, v142, v143
  buffer_load_dwordx4 v81, s[20:23], s12 offen offset:1024  lds
  s_waitcnt lgkmcnt(7)
  v_mfma_f32_32x32x16_bf16 v[128:143], v[104:107], v[32:35], 0
  v_exp_f32 v144, v144
  v_exp_f32 v145, v145
  v_exp_f32 v146, v146
  v_exp_f32 v147, v147
  s_waitcnt lgkmcnt(6)
  v_mfma_f32_32x32x16_bf16 v[128:143], v[108:111], v[36:39], v[128:143]
  ds_read_b128 v[96:99], v6 offset:8192
  ds_read_b128 v[100:103], v6 offset:9216
  v_exp_f32 v148, v148
  v_exp_f32 v149, v149
  v_exp_f32 v150, v150
  v_exp_f32 v151, v151
  v_cvt_pk_bf16_f32 v168, v144, v145
  v_cvt_pk_bf16_f32 v169, v146, v147
  buffer_load_dwordx4 v82, s[20:23], s12 offen offset:2048  lds
  s_waitcnt lgkmcnt(7)
  v_mfma_f32_32x32x16_bf16 v[176:191], v[224:227], v[160:163], v[176:191]
  v_exp_f32 v152, v152
  v_exp_f32 v153, v153
  v_exp_f32 v154, v154
  v_exp_f32 v155, v155
  v_cvt_pk_bf16_f32 v170, v148, v149
  v_cvt_pk_bf16_f32 v171, v150, v151
  buffer_load_dwordx4 v83, s[20:23], s12 offen offset:3072  lds
  s_waitcnt lgkmcnt(6)
  v_mfma_f32_32x32x16_bf16 v[176:191], v[228:231], v[164:167], v[176:191]
  ds_read_b128 v[224:227], v6 offset:18432
  ds_read_b128 v[228:231], v6 offset:19456
  v_exp_f32 v156, v156
  v_exp_f32 v157, v157
  v_exp_f32 v158, v158
  v_exp_f32 v159, v159
  v_cvt_pk_bf16_f32 v172, v152, v153
  v_cvt_pk_bf16_f32 v173, v154, v155
  v_cvt_pk_bf16_f32 v174, v156, v157
  v_cvt_pk_bf16_f32 v175, v158, v159
  s_add_u32 m0, s13, 49152
  s_add_u32 s12, s69, 688128
  buffer_load_dwordx4 v80, s[20:23], s12 offen offset:0  lds
  s_waitcnt lgkmcnt(7)
  v_mfma_f32_32x32x16_bf16 v[144:159], v[112:115], v[32:35], 0
  v_exp_f32 v128, v128
  v_exp_f32 v129, v129
  v_exp_f32 v130, v130
  v_exp_f32 v131, v131
  s_waitcnt lgkmcnt(6)
  v_mfma_f32_32x32x16_bf16 v[144:159], v[116:119], v[36:39], v[144:159]
  ds_read_b128 v[104:107], v6 offset:4096
  ds_read_b128 v[108:111], v6 offset:5120
  v_exp_f32 v132, v132
  v_exp_f32 v133, v133
  v_exp_f32 v134, v134
  v_exp_f32 v135, v135
  v_cvt_pk_bf16_f32 v160, v128, v129
  v_cvt_pk_bf16_f32 v161, v130, v131
  buffer_load_dwordx4 v81, s[20:23], s12 offen offset:1024  lds
  s_waitcnt lgkmcnt(7)
  v_mfma_f32_32x32x16_bf16 v[176:191], v[232:235], v[168:171], v[176:191]
  v_exp_f32 v136, v136
  v_exp_f32 v137, v137
  v_exp_f32 v138, v138
  v_exp_f32 v139, v139
  v_cvt_pk_bf16_f32 v162, v132, v133
  v_cvt_pk_bf16_f32 v163, v134, v135
  buffer_load_dwordx4 v82, s[20:23], s12 offen offset:2048  lds
  s_waitcnt lgkmcnt(6)
  v_mfma_f32_32x32x16_bf16 v[176:191], v[236:239], v[172:175], v[176:191]
  ds_read_b128 v[232:235], v6 offset:14336
  ds_read_b128 v[236:239], v6 offset:15360
  v_exp_f32 v140, v140
  v_exp_f32 v141, v141
  v_exp_f32 v142, v142
  v_exp_f32 v143, v143
  v_cvt_pk_bf16_f32 v164, v136, v137
  v_cvt_pk_bf16_f32 v165, v138, v139
  v_cvt_pk_bf16_f32 v166, v140, v141
  v_cvt_pk_bf16_f32 v167, v142, v143
  buffer_load_dwordx4 v83, s[20:23], s12 offen offset:3072  lds
  s_waitcnt lgkmcnt(7)
  v_mfma_f32_32x32x16_bf16 v[128:143], v[96:99], v[32:35], 0
  v_exp_f32 v144, v144
  v_exp_f32 v145, v145
  v_exp_f32 v146, v146
  v_exp_f32 v147, v147
  s_waitcnt lgkmcnt(6)
  v_mfma_f32_32x32x16_bf16 v[128:143], v[100:103], v[36:39], v[128:143]
  ds_read_b128 v[112:115], v6 offset:0
  ds_read_b128 v[116:119], v6 offset:1024
  v_exp_f32 v148, v148
  v_exp_f32 v149, v149
  v_exp_f32 v150, v150
  v_exp_f32 v151, v151
  v_cvt_pk_bf16_f32 v168, v144, v145
  v_cvt_pk_bf16_f32 v169, v146, v147
  s_add_u32 m0, s13, 65536
  s_add_u32 s12, s69, 917504
  buffer_load_dwordx4 v80, s[20:23], s12 offen offset:0  lds
  s_waitcnt lgkmcnt(7)
  v_mfma_f32_32x32x16_bf16 v[176:191], v[224:227], v[160:163], v[176:191]
  v_exp_f32 v152, v152
  v_exp_f32 v153, v153
  v_exp_f32 v154, v154
  v_exp_f32 v155, v155
  v_cvt_pk_bf16_f32 v170, v148, v149
  v_cvt_pk_bf16_f32 v171, v150, v151
  buffer_load_dwordx4 v81, s[20:23], s12 offen offset:1024  lds
  s_waitcnt lgkmcnt(6)
  v_mfma_f32_32x32x16_bf16 v[176:191], v[228:231], v[164:167], v[176:191]
  ds_read_b128 v[224:227], v6 offset:10240
  ds_read_b128 v[228:231], v6 offset:11264
  v_exp_f32 v156, v156
  v_exp_f32 v157, v157
  v_exp_f32 v158, v158
  v_exp_f32 v159, v159
  v_cvt_pk_bf16_f32 v172, v152, v153
  v_cvt_pk_bf16_f32 v173, v154, v155
  v_cvt_pk_bf16_f32 v174, v156, v157
  v_cvt_pk_bf16_f32 v175, v158, v159
  buffer_load_dwordx4 v82, s[20:23], s12 offen offset:2048  lds
  s_waitcnt lgkmcnt(7)
  v_mfma_f32_32x32x16_bf16 v[144:159], v[104:107], v[32:35], 0
  v_exp_f32 v128, v128
  v_exp_f32 v129, v129
  v_exp_f32 v130, v130
  v_exp_f32 v131, v131
  s_waitcnt lgkmcnt(6)
  v_mfma_f32_32x32x16_bf16 v[144:159], v[108:111], v[36:39], v[144:159]
  v_exp_f32 v132, v132
  v_exp_f32 v133, v133
  v_exp_f32 v134, v134
  v_exp_f32 v135, v135
  v_cvt_pk_bf16_f32 v160, v128, v129
  v_cvt_pk_bf16_f32 v161, v130, v131
  buffer_load_dwordx4 v83, s[20:23], s12 offen offset:3072  lds
  s_waitcnt lgkmcnt(5)
  v_mfma_f32_32x32x16_bf16 v[176:191], v[232:235], v[168:171], v[176:191]
  v_exp_f32 v136, v136
  v_exp_f32 v137, v137
  v_exp_f32 v138, v138
  v_exp_f32 v139, v139
  v_cvt_pk_bf16_f32 v162, v132, v133
  v_cvt_pk_bf16_f32 v163, v134, v135
  s_add_u32 m0, s13, 81920
  s_add_u32 s12, s69, 1146880
  buffer_load_dwordx4 v80, s[20:23], s12 offen offset:0  lds
  s_waitcnt lgkmcnt(4)
  v_mfma_f32_32x32x16_bf16 v[176:191], v[236:239], v[172:175], v[176:191]
  ds_read_b128 v[232:235], v6 offset:6144
  ds_read_b128 v[236:239], v6 offset:7168
  v_exp_f32 v140, v140
  v_exp_f32 v141, v141
  v_exp_f32 v142, v142
  v_exp_f32 v143, v143
  v_cvt_pk_bf16_f32 v164, v136, v137
  v_cvt_pk_bf16_f32 v165, v138, v139
  v_cvt_pk_bf16_f32 v166, v140, v141
  v_cvt_pk_bf16_f32 v167, v142, v143
  buffer_load_dwordx4 v81, s[20:23], s12 offen offset:1024  lds
  s_waitcnt lgkmcnt(5)
  v_mfma_f32_32x32x16_bf16 v[128:143], v[112:115], v[32:35], v[192:207]
  v_exp_f32 v144, v144
  v_exp_f32 v145, v145
  v_exp_f32 v146, v146
  v_exp_f32 v147, v147
  s_waitcnt lgkmcnt(4)
  v_mfma_f32_32x32x16_bf16 v[128:143], v[116:119], v[36:39], v[128:143]
  v_exp_f32 v148, v148
  v_exp_f32 v149, v149
  v_exp_f32 v150, v150
  v_exp_f32 v151, v151
  v_cvt_pk_bf16_f32 v168, v144, v145
  v_cvt_pk_bf16_f32 v169, v146, v147
  buffer_load_dwordx4 v82, s[20:23], s12 offen offset:2048  lds
  s_waitcnt lgkmcnt(3)
  v_mfma_f32_32x32x16_bf16 v[176:191], v[224:227], v[160:163], v[176:191]
  v_exp_f32 v152, v152
  v_exp_f32 v153, v153
  v_exp_f32 v154, v154
  v_exp_f32 v155, v155
  v_cvt_pk_bf16_f32 v170, v148, v149
  v_cvt_pk_bf16_f32 v171, v150, v151
  s_waitcnt lgkmcnt(2)
  v_mfma_f32_32x32x16_bf16 v[176:191], v[228:231], v[164:167], v[176:191]
  ds_read_b128 v[224:227], v6 offset:2048
  ds_read_b128 v[228:231], v6 offset:3072
  v_exp_f32 v156, v156
  v_exp_f32 v157, v157
  v_exp_f32 v158, v158
  v_exp_f32 v159, v159
  v_cvt_pk_bf16_f32 v172, v152, v153
  v_cvt_pk_bf16_f32 v173, v154, v155
  v_cvt_pk_bf16_f32 v174, v156, v157
  v_cvt_pk_bf16_f32 v175, v158, v159
  buffer_load_dwordx4 v83, s[20:23], s12 offen offset:3072  lds
  s_waitcnt lgkmcnt(3)
  v_mfma_f32_32x32x16_bf16 v[176:191], v[232:235], v[168:171], v[176:191]
  v_exp_f32 v128, v128
  v_exp_f32 v129, v129
  v_exp_f32 v130, v130
  v_exp_f32 v131, v131
  s_waitcnt lgkmcnt(2)
  v_mfma_f32_32x32x16_bf16 v[176:191], v[236:239], v[172:175], v[176:191]
  v_exp_f32 v132, v132
  v_exp_f32 v133, v133
  v_exp_f32 v134, v134
  v_exp_f32 v135, v135
  v_cvt_pk_bf16_f32 v160, v128, v129
  v_cvt_pk_bf16_f32 v161, v130, v131
  v_exp_f32 v136, v136
  v_exp_f32 v137, v137
  v_exp_f32 v138, v138
  v_exp_f32 v139, v139
  v_cvt_pk_bf16_f32 v162, v132, v133
  v_cvt_pk_bf16_f32 v163, v134, v135
  s_waitcnt lgkmcnt(1)
  s_nop 0
  v_mfma_f32_32x32x16_bf16 v[176:191], v[224:227], v[160:163], v[176:191]
  v_exp_f32 v140, v140
  v_exp_f32 v141, v141
  v_exp_f32 v142, v142
  v_exp_f32 v143, v143
  v_cvt_pk_bf16_f32 v164, v136, v137
  v_cvt_pk_bf16_f32 v165, v138, v139
  v_cvt_pk_bf16_f32 v166, v140, v141
  v_cvt_pk_bf16_f32 v167, v142, v143
  s_waitcnt lgkmcnt(0)
  s_nop 0
  v_mfma_f32_32x32x16_bf16 v[176:191], v[228:231], v[164:167], v[176:191]
  s_lshr_b32 s64, s5, 3
  s_and_b32 s65, s3, 1
  s_lshl1_add_u32 s64, s64, s65
  s_mul_i32 s64, s64, 0
  s_xor_b32 s73, s73, s64
  s_xor_b32 s10, s73, 1024
  v_bfe_u32 v244, v0, 2, 2
  v_lshrrev_b32 v245, 5, v0
  v_lshl_add_u32 v245, v245, 2, v244
  v_lshlrev_b32 v245, 8, v245
  v_lshl_add_u32 v245, v244, 6, v245
  v_and_b32 v244, 3, v0
  v_lshl_add_u32 v245, v244, 3, v245
  v_bfe_u32 v244, v0, 4, 1
  v_lshl_add_u32 v10, v244, 5, v245
  v_mov_b32 v240, v188
  v_mov_b32 v241, v188
  v_xor_b32 v11, 64, v10
  v_xor_b32 v12, 128, v10
  v_permlane32_swap_b32 v240, v241
  v_cmp_ngt_f32 vcc, 0x53800000, v241
  v_xor_b32 v13, 192, v10
  s_cmp_lg_u64 vcc, 0
  s_cbranch_scc1 L_p2slow
L_p2back:
  v_rcp_f32 v240, v241
  s_nop 0
  v_pk_mul_f32 v[176:177], v[176:177], v[240:241] op_sel_hi:[1,0]
  v_pk_mul_f32 v[178:179], v[178:179], v[240:241] op_sel_hi:[1,0]
  v_pk_mul_f32 v[180:181], v[180:181], v[240:241] op_sel_hi:[1,0]
  v_pk_mul_f32 v[182:183], v[182:183], v[240:241] op_sel_hi:[1,0]
  v_cvt_pk_bf16_f32 v160, v176, v177
  v_cvt_pk_bf16_f32 v161, v178, v179
  v_cvt_pk_bf16_f32 v162, v180, v181
  v_cvt_pk_bf16_f32 v163, v182, v183
  buffer_store_dwordx4 v[160:163], v2, s[48:51], s73 offen
  v_pk_mul_f32 v[184:185], v[184:185], v[240:241] op_sel_hi:[1,0]
  v_pk_mul_f32 v[186:187], v[186:187], v[240:241] op_sel_hi:[1,0]
  v_pk_mul_f32 v[188:189], v[188:189], v[240:241] op_sel_hi:[1,0]
  v_pk_mul_f32 v[190:191], v[190:191], v[240:241] op_sel_hi:[1,0]
  v_cvt_pk_bf16_f32 v164, v184, v185
  v_cvt_pk_bf16_f32 v165, v186, v187
  v_cvt_pk_bf16_f32 v166, v188, v189
  v_cvt_pk_bf16_f32 v167, v190, v191
  v_cndmask_b32 v166, v166, v246, s[62:63]
  v_cndmask_b32 v167, v167, v246, s[62:63]
  buffer_store_dwordx4 v[164:167], v2, s[48:51], s10 offen
  s_cmp_ge_u32 s5, 14
  s_cbranch_scc1 L_helper
  s_branch L_pg_9
  .p2align 12
L_pg_9:
L_p3:
  s_add_u32 m0, s13, 98304
  s_add_u32 s12, s69, 1376256
  buffer_load_dwordx4 v80, s[20:23], s12 offen offset:0  lds
  buffer_load_dwordx4 v81, s[20:23], s12 offen offset:1024  lds
  buffer_load_dwordx4 v82, s[20:23], s12 offen offset:2048  lds
  buffer_load_dwordx4 v83, s[20:23], s12 offen offset:3072  lds
  v_add_u32 v88, 57344, v10
  v_add_u32 v89, 57344, v11
  v_add_u32 v90, 57344, v12
  v_add_u32 v91, 57344, v13
  v_add_u32 v243, s71, v247
  v_add_u32 v243, 160256, v243
  v_add_u32 v255, 6144, v1
  s_and_b32 s64, s3, 1
  s_lshl1_add_u32 s64, s66, s64
  s_lshr_b32 s65, s3, 1
  s_lshl1_add_u32 s70, s64, s65
  s_lshl_b32 s73, s70, 14
  s_lshl_b32 s70, s70, 5
  s_add_u32 s70, s70, s60
  s_add_u32 s70, s70, 522240
  s_add_u32 s73, s73, s60
  s_add_u32 s73, s73, 262144
  v_and_b32 v240, 7, v0
  v_lshlrev_b32 v240, 2, v240
  s_mov_b32 s36, 0
  s_add_u32 s37, s36, 16384
  s_cmp_eq_u32 s37, 114688
  s_cselect_b32 s37, 0, s37
  s_add_u32 s38, s37, 16384
  s_cmp_eq_u32 s38, 114688
  s_cselect_b32 s38, 0, s38
  s_add_u32 s39, s38, 16384
  s_cmp_eq_u32 s39, 114688
  s_cselect_b32 s39, 0, s39
  s_add_u32 s40, s39, 16384
  s_cmp_eq_u32 s40, 114688
  s_cselect_b32 s40, 0, s40
  s_add_u32 s41, s40, 16384
  s_cmp_eq_u32 s41, 114688
  s_cselect_b32 s41, 0, s41
  s_add_u32 s42, s41, 16384
  s_cmp_eq_u32 s42, 114688
  s_cselect_b32 s42, 0, s42
  s_cmp_lg_u32 s7, 0
  s_mov_b64 exec, 1
  s_waitcnt vmcnt(4)
  s_cbranch_scc1 L_rel_10
  buffer_store_dword v3, off, s[48:51], s74 offset:0
L_rel_10r:
  s_mov_b64 exec, -1
  v_xor_b32 v64, s6, v58
  v_xor_b32 v65, s6, v62
  v_or_b32 v64, v64, v65
  v_cmp_ne_u32 vcc, 0, v64
  s_nop 0
  s_cmp_lg_u64 vcc, 0
  s_cbranch_scc1 L_chk_11
L_chk_11r:
  ds_write_b64 v254, v[56:57]
  ds_write_b64 v254, v[60:61] offset:448
  s_mul_i32 s74, s3, 10240
  s_add_u32 s74, s74, 114688
  v_add_u32 v14, s74, v4
  v_add_u32 v15, s74, v5
  v_lshl_add_u32 v4, s3, 10, v2
  v_xor_b32 v5, 1024, v4
  v_xor_b32 v6, 2048, v4
  v_xor_b32 v7, 3072, v4
  s_waitcnt lgkmcnt(0)
  s_barrier
  ds_read_b128 v[192:195], v243 offset:0
  ds_read_b128 v[200:203], v243 offset:1792
  ds_read_b128 v[196:199], v243 offset:32
  ds_read_b128 v[204:207], v243 offset:1824
  s_mul_i32 s61, s36, 14
  s_add_u32 m0, s74, 4096
  s_add_u32 s61, s61, s77
  buffer_load_dwordx4 v1, s[28:31], s61 offen  lds
  buffer_load_dwordx4 v255, s[28:31], s61 offen offset:1024  lds
  v_lshlrev_b32 v64, 16, v16
  v_and_b32 v65, 0xffff0000, v16
  v_lshlrev_b32 v66, 16, v17
  v_and_b32 v67, 0xffff0000, v17
  v_lshlrev_b32 v68, 16, v18
  v_and_b32 v69, 0xffff0000, v18
  v_lshlrev_b32 v70, 16, v19
  v_and_b32 v71, 0xffff0000, v19
  v_lshlrev_b32 v72, 16, v20
  v_and_b32 v73, 0xffff0000, v20
  v_lshlrev_b32 v74, 16, v21
  v_and_b32 v75, 0xffff0000, v21
  v_lshlrev_b32 v76, 16, v22
  v_and_b32 v77, 0xffff0000, v22
  v_lshlrev_b32 v78, 16, v23
  v_and_b32 v79, 0xffff0000, v23
  s_mov_b32 s68, 0
L_poll_12:
  buffer_load_dword v241, v240, s[48:51], s70 offen sc1
  s_add_u32 s68, s68, 1
  s_cmp_ge_u32 s68, 1048576
  s_cbranch_scc1 L_end
  s_waitcnt vmcnt(0)
  v_cmp_ne_u32 vcc, s6, v241
  s_nop 0
  s_cmp_lg_u64 vcc, 0
  s_cbranch_scc1 L_poll_12
  s_cmp_lg_u32 s7, 0
  s_cbranch_scc1 L_acq_13
L_acq_13r:
  buffer_load_dwordx4 v[96:99], v2, s[48:51], s73 offen offset:0 sc1
  buffer_load_dwordx4 v[100:103], v2, s[48:51], s73 offen offset:1024 sc1
  buffer_load_dwordx4 v[104:107], v2, s[48:51], s73 offen offset:2048 sc1
  buffer_load_dwordx4 v[108:111], v2, s[48:51], s73 offen offset:3072 sc1
  s_add_u32 s73, s73, 4096
  buffer_load_dwordx4 v[112:115], v2, s[48:51], s73 offen offset:0 sc1
  buffer_load_dwordx4 v[116:119], v2, s[48:51], s73 offen offset:1024 sc1
  s_waitcnt vmcnt(5)
  v_mfma_f32_32x32x16_bf16 v[176:191], a[4:7], v[96:99], 0
  buffer_load_dwordx4 v[120:123], v2, s[48:51], s73 offen offset:2048 sc1
  v_mfma_f32_32x32x16_bf16 v[160:175], a[0:3], v[96:99], 0
  ds_read_b64_tr_b16 a[128:129], v14 offset:4096
  ds_read_b64_tr_b16 a[130:131], v14 offset:5120
  ds_read_b64_tr_b16 a[132:133], v15 offset:4096
  ds_read_b64_tr_b16 a[134:135], v15 offset:5120
  s_waitcnt vmcnt(5)
  v_mfma_f32_32x32x16_bf16 v[176:191], a[12:15], v[100:103], v[176:191]
  buffer_load_dwordx4 v[124:127], v2, s[48:51], s73 offen offset:3072 sc1
  v_mfma_f32_32x32x16_bf16 v[160:175], a[8:11], v[100:103], v[160:175]
  s_waitcnt lgkmcnt(7)
  v_lshlrev_b32 v32, 16, v192
  v_and_b32 v33, 0xffff0000, v192
  v_lshlrev_b32 v34, 16, v193
  v_and_b32 v35, 0xffff0000, v193
  s_waitcnt vmcnt(5)
  v_mfma_f32_32x32x16_bf16 v[176:191], a[20:23], v[104:107], v[176:191]
  s_add_u32 s73, s73, 4096
  buffer_load_dwordx4 v[128:131], v2, s[48:51], s73 offen offset:0 sc1
  v_mfma_f32_32x32x16_bf16 v[160:175], a[16:19], v[104:107], v[160:175]
  v_lshlrev_b32 v36, 16, v194
  v_and_b32 v37, 0xffff0000, v194
  v_lshlrev_b32 v38, 16, v195
  v_and_b32 v39, 0xffff0000, v195
  s_waitcnt vmcnt(5)
  v_mfma_f32_32x32x16_bf16 v[176:191], a[28:31], v[108:111], v[176:191]
  buffer_load_dwordx4 v[132:135], v2, s[48:51], s73 offen offset:1024 sc1
  v_mfma_f32_32x32x16_bf16 v[160:175], a[24:27], v[108:111], v[160:175]
  s_waitcnt lgkmcnt(5)
  v_lshlrev_b32 v40, 16, v196
  v_and_b32 v41, 0xffff0000, v196
  v_lshlrev_b32 v42, 16, v197
  v_and_b32 v43, 0xffff0000, v197
  s_waitcnt vmcnt(5)
  v_mfma_f32_32x32x16_bf16 v[176:191], a[36:39], v[112:115], v[176:191]
  buffer_load_dwordx4 v[136:139], v2, s[48:51], s73 offen offset:2048 sc1
  v_mfma_f32_32x32x16_bf16 v[160:175], a[32:35], v[112:115], v[160:175]
  v_lshlrev_b32 v44, 16, v198
  v_and_b32 v45, 0xffff0000, v198
  v_lshlrev_b32 v46, 16, v199
  v_and_b32 v47, 0xffff0000, v199
  s_waitcnt vmcnt(5)
  v_mfma_f32_32x32x16_bf16 v[176:191], a[44:47], v[116:119], v[176:191]
  buffer_load_dwordx4 v[140:143], v2, s[48:51], s73 offen offset:3072 sc1
  v_mfma_f32_32x32x16_bf16 v[160:175], a[40:43], v[116:119], v[160:175]
  v_lshlrev_b32 v48, 16, v200
  v_and_b32 v49, 0xffff0000, v200
  v_lshlrev_b32 v50, 16, v201
  v_and_b32 v51, 0xffff0000, v201
  s_waitcnt vmcnt(5)
  v_mfma_f32_32x32x16_bf16 v[176:191], a[52:55], v[120:123], v[176:191]
  s_add_u32 s73, s73, 4096
  buffer_load_dwordx4 v[144:147], v2, s[48:51], s73 offen offset:0 sc1
  v_mfma_f32_32x32x16_bf16 v[160:175], a[48:51], v[120:123], v[160:175]
  v_lshlrev_b32 v52, 16, v202
  v_and_b32 v53, 0xffff0000, v202
  v_lshlrev_b32 v54, 16, v203
  v_and_b32 v55, 0xffff0000, v203
  s_waitcnt vmcnt(5)
  v_mfma_f32_32x32x16_bf16 v[176:191], a[60:63], v[124:127], v[176:191]
  buffer_load_dwordx4 v[148:151], v2, s[48:51], s73 offen offset:1024 sc1
  v_mfma_f32_32x32x16_bf16 v[160:175], a[56:59], v[124:127], v[160:175]
  s_waitcnt lgkmcnt(4)
  v_lshlrev_b32 v56, 16, v204
  v_and_b32 v57, 0xffff0000, v204
  v_lshlrev_b32 v58, 16, v205
  v_and_b32 v59, 0xffff0000, v205
  s_waitcnt vmcnt(5)
  v_mfma_f32_32x32x16_bf16 v[176:191], a[68:71], v[128:131], v[176:191]
  buffer_load_dwordx4 v[152:155], v2, s[48:51], s73 offen offset:2048 sc1
  v_mfma_f32_32x32x16_bf16 v[160:175], a[64:67], v[128:131], v[160:175]
  v_lshlrev_b32 v60, 16, v206
  v_and_b32 v61, 0xffff0000, v206
  v_lshlrev_b32 v62, 16, v207
  v_and_b32 v63, 0xffff0000, v207
  s_waitcnt vmcnt(5)
  v_mfma_f32_32x32x16_bf16 v[176:191], a[76:79], v[132:135], v[176:191]
  buffer_load_dwordx4 v[156:159], v2, s[48:51], s73 offen offset:3072 sc1
  v_mfma_f32_32x32x16_bf16 v[160:175], a[72:75], v[132:135], v[160:175]
  v_add_u32 v240, s74, v2
  s_xor_b32 s63, s3, 2
  s_mul_i32 s63, s63, 10240
  s_add_u32 s63, s63, 114688
  s_waitcnt vmcnt(5)
  v_mfma_f32_32x32x16_bf16 v[176:191], a[84:87], v[136:139], v[176:191]
  s_waitcnt lgkmcnt(0)
  s_mul_i32 s61, s37, 14
  s_add_u32 m0, s74, 4096
  s_add_u32 s61, s61, s77
  buffer_load_dwordx4 v1, s[28:31], s61 offen  lds
  v_mfma_f32_32x32x16_bf16 v[160:175], a[80:83], v[136:139], v[160:175]
  v_add_u32 v241, s63, v2
  s_lshl1_add_u32 s63, s67, s65
  s_mul_i32 s71, s64, 14
  s_add_u32 s71, s71, s63
  s_waitcnt vmcnt(5)
  v_mfma_f32_32x32x16_bf16 v[176:191], a[92:95], v[140:143], v[176:191]
  buffer_load_dwordx4 v255, s[28:31], s61 offen offset:1024  lds
  v_mfma_f32_32x32x16_bf16 v[160:175], a[88:91], v[140:143], v[160:175]
  s_lshl4_add_u32 s72, s64, s63
  s_lshl2_add_u32 s72, s72, s60
  s_add_u32 s72, s72, 522496
  s_lshl_b32 s71, s71, 8
  s_waitcnt vmcnt(5)
  v_mfma_f32_32x32x16_bf16 v[176:191], a[100:103], v[144:147], v[176:191]
  s_mul_i32 s61, s38, 14
  s_add_u32 m0, s74, 6144
  s_add_u32 s61, s61, s77
  buffer_load_dwordx4 v1, s[28:31], s61 offen  lds
  v_mfma_f32_32x32x16_bf16 v[160:175], a[96:99], v[144:147], v[160:175]
  s_add_u32 s71, s71, s60
  s_add_u32 s71, s71, 507904
  v_lshlrev_b32 v242, 2, v0
  s_mul_i32 s63, s64, 1024
  s_waitcnt vmcnt(5)
  v_mfma_f32_32x32x16_bf16 v[176:191], a[108:111], v[148:151], v[176:191]
  buffer_load_dwordx4 v255, s[28:31], s61 offen offset:1024  lds
  s_waitcnt vmcnt(5)
  v_mfma_f32_32x32x16_bf16 v[176:191], a[116:119], v[152:155], v[176:191]
  s_mul_i32 s61, s39, 14
  s_add_u32 m0, s74, 8192
  s_add_u32 s61, s61, s77
  buffer_load_dwordx4 v1, s[28:31], s61 offen  lds
  s_waitcnt vmcnt(5)
  v_mfma_f32_32x32x16_bf16 v[176:191], a[124:127], v[156:159], v[176:191]
  buffer_load_dwordx4 v255, s[28:31], s61 offen offset:1024  lds
  v_mfma_f32_32x32x16_bf16 v[160:175], a[104:107], v[148:151], v[160:175]
  s_xor_b32 s14, s14, s63
  s_xor_b32 s15, s14, 1024
  v_mfma_f32_32x32x16_bf16 v[160:175], a[112:115], v[152:155], v[160:175]
  v_mfma_f32_32x32x16_bf16 v[160:175], a[120:123], v[156:159], v[160:175]
  s_nop 5
  ds_write_b128 v241, v[176:179] offset:0
  ds_write_b128 v241, v[180:183] offset:1024
  ds_write_b128 v241, v[184:187] offset:2048
  ds_write_b128 v241, v[188:191] offset:3072
  s_waitcnt lgkmcnt(0)
  s_barrier
  ds_read_b128 v[176:179], v240 offset:0
  ds_read_b128 v[180:183], v240 offset:1024
  ds_read_b128 v[184:187], v240 offset:2048
  ds_read_b128 v[188:191], v240 offset:3072
  v_pk_fma_f32 v[64:65], v[160:161], v[32:33], v[64:65]
  v_pk_fma_f32 v[66:67], v[162:163], v[34:35], v[66:67]
  v_pk_fma_f32 v[68:69], v[164:165], v[36:37], v[68:69]
  v_pk_fma_f32 v[70:71], v[166:167], v[38:39], v[70:71]
  v_pk_fma_f32 v[72:73], v[168:169], v[40:41], v[72:73]
  v_pk_fma_f32 v[74:75], v[170:171], v[42:43], v[74:75]
  v_pk_fma_f32 v[76:77], v[172:173], v[44:45], v[76:77]
  v_pk_fma_f32 v[78:79], v[174:175], v[46:47], v[78:79]
  s_waitcnt lgkmcnt(3)
  v_pk_fma_f32 v[64:65], v[176:177], v[32:33], v[64:65]
  v_pk_fma_f32 v[66:67], v[178:179], v[34:35], v[66:67]
  s_waitcnt lgkmcnt(2)
  v_pk_fma_f32 v[68:69], v[180:181], v[36:37], v[68:69]
  v_pk_fma_f32 v[70:71], v[182:183], v[38:39], v[70:71]
  v_pk_mul_f32 v[160:161], v[64:65], v[48:49]
  v_pk_mul_f32 v[162:163], v[66:67], v[50:51]
  v_pk_mul_f32 v[164:165], v[68:69], v[52:53]
  v_pk_mul_f32 v[166:167], v[70:71], v[54:55]
  v_cvt_pk_bf16_f32 v96, v160, v161
  v_cvt_pk_bf16_f32 v97, v162, v163
  v_cvt_pk_bf16_f32 v98, v164, v165
  v_cvt_pk_bf16_f32 v99, v166, v167
  buffer_store_dwordx4 v[96:99], v2, s[44:47], s14 offen
  s_waitcnt lgkmcnt(1)
  v_pk_fma_f32 v[72:73], v[184:185], v[40:41], v[72:73]
  v_pk_fma_f32 v[74:75], v[186:187], v[42:43], v[74:75]
  s_waitcnt lgkmcnt(0)
  v_pk_fma_f32 v[76:77], v[188:189], v[44:45], v[76:77]
  v_pk_fma_f32 v[78:79], v[190:191], v[46:47], v[78:79]
  v_pk_mul_f32 v[168:169], v[72:73], v[56:57]
  v_pk_mul_f32 v[170:171], v[74:75], v[58:59]
  v_pk_mul_f32 v[172:173], v[76:77], v[60:61]
  v_pk_mul_f32 v[174:175], v[78:79], v[62:63]
  v_cvt_pk_bf16_f32 v100, v168, v169
  v_cvt_pk_bf16_f32 v101, v170, v171
  v_cvt_pk_bf16_f32 v102, v172, v173
  v_cvt_pk_bf16_f32 v103, v174, v175
  buffer_store_dwordx4 v[100:103], v2, s[44:47], s15 offen
  v_pk_add_f32 v[244:245], v[64:65], v[66:67]
  v_pk_mul_f32 v[246:247], v[64:65], v[64:65]
  v_pk_fma_f32 v[246:247], v[66:67], v[66:67], v[246:247]
  v_pk_add_f32 v[244:245], v[244:245], v[68:69]
  v_pk_fma_f32 v[246:247], v[68:69], v[68:69], v[246:247]
  v_pk_add_f32 v[244:245], v[244:245], v[70:71]
  v_pk_fma_f32 v[246:247], v[70:71], v[70:71], v[246:247]
  v_pk_add_f32 v[244:245], v[244:245], v[72:73]
  v_pk_fma_f32 v[246:247], v[72:73], v[72:73], v[246:247]
  v_pk_add_f32 v[244:245], v[244:245], v[74:75]
  v_pk_fma_f32 v[246:247], v[74:75], v[74:75], v[246:247]
  v_pk_add_f32 v[244:245], v[244:245], v[76:77]
  v_pk_fma_f32 v[246:247], v[76:77], v[76:77], v[246:247]
  v_pk_add_f32 v[244:245], v[244:245], v[78:79]
  v_pk_fma_f32 v[246:247], v[78:79], v[78:79], v[246:247]
  v_add_f32 v244, v244, v245
  v_add_f32 v245, v246, v247
  s_nop 1
  v_permlane32_swap_b32 v244, v245
  v_add_f32 v244, v244, v245
  buffer_store_dword v244, v242, s[48:51], s71 offen
  v_lshlrev_b32 v245, 3, v0
  s_lshl_b32 s56, s5, 11
  s_add_u32 s56, s56, 262144
  ds_read_b128 v[80:83], v243 offset:2688
  ds_read_b128 v[84:87], v243 offset:2720
  s_lshl_b32 s70, s3, 6
  s_add_u32 s70, s70, s60
  s_add_u32 s70, s70, 522496
  v_min_u32 v240, 13, v0
  v_lshlrev_b32 v240, 2, v240
  s_lshl2_add_u32 s73, s4, s3
  s_mul_i32 s73, s73, 28672
  s_mul_i32 s71, s3, 3584
  s_add_u32 s71, s71, s60
  s_add_u32 s71, s71, 507904
  v_add_u32 v242, s74, v242
  s_waitcnt vmcnt(7)
  ds_read_b64_tr_b16 a[136:137], v14 offset:4096
  ds_read_b64_tr_b16 a[138:139], v14 offset:5120
  ds_read_b64_tr_b16 a[140:141], v15 offset:4096
  ds_read_b64_tr_b16 a[142:143], v15 offset:5120
  s_waitcnt vmcnt(5)
  ds_read_b64_tr_b16 a[144:145], v14 offset:6144
  ds_read_b64_tr_b16 a[146:147], v14 offset:7168
  ds_read_b64_tr_b16 a[148:149], v15 offset:6144
  ds_read_b64_tr_b16 a[150:151], v15 offset:7168
  s_waitcnt vmcnt(3)
  ds_read_b64_tr_b16 a[152:153], v14 offset:8192
  ds_read_b64_tr_b16 a[154:155], v14 offset:9216
  ds_read_b64_tr_b16 a[156:157], v15 offset:8192
  ds_read_b64_tr_b16 a[158:159], v15 offset:9216
  s_cmp_lg_u32 s7, 0
  s_mov_b64 exec, 1
  s_waitcnt vmcnt(0)
  s_cbranch_scc1 L_rel_14
  buffer_store_dword v3, off, s[48:51], s72 offset:0
L_rel_14r:
  s_mov_b64 exec, -1
  s_waitcnt lgkmcnt(8)
  s_mul_i32 s61, s40, 14
  s_add_u32 m0, s74, 4096
  s_add_u32 s61, s61, s77
  buffer_load_dwordx4 v1, s[28:31], s61 offen  lds
  buffer_load_dwordx4 v255, s[28:31], s61 offen offset:1024  lds
  s_waitcnt lgkmcnt(4)
  s_mul_i32 s61, s41, 14
  s_add_u32 m0, s74, 6144
  s_add_u32 s61, s61, s77
  buffer_load_dwordx4 v1, s[28:31], s61 offen  lds
  buffer_load_dwordx4 v255, s[28:31], s61 offen offset:1024  lds
  s_waitcnt lgkmcnt(0)
  s_mul_i32 s61, s42, 14
  s_add_u32 m0, s74, 8192
  s_add_u32 s61, s61, s77
  buffer_load_dwordx4 v1, s[28:31], s61 offen  lds
  buffer_load_dwordx4 v255, s[28:31], s61 offen offset:1024  lds
  s_mul_i32 s75, s3, 114688
  s_lshl_b32 s63, s5, 13
  s_add_u32 s75, s75, s63
  s_add_u32 s75, s75, s60
  s_add_u32 s75, s75, 524288
  s_and_b32 s63, s5, 1
  s_lshl_b32 s63, s63, 11
  s_add_u32 s75, s75, s63
  s_lshl4_add_u32 s8, s3, s5
  s_lshl_b32 s59, s8, 11
  s_add_u32 s59, s59, s60
  s_add_u32 s59, s59, 262144
  s_lshl2_add_u32 s8, s8, s60
  s_add_u32 s8, s8, 523264
  s_lshl_b32 s10, s66, 7
  s_add_u32 s10, s10, s60
  s_add_u32 s10, s10, 523264
  v_and_b32 v249, 15, v0
  v_min_u32 v249, 13, v249
  v_and_b32 v246, 16, v0
  v_add_lshl_u32 v249, v249, v246, 2
  s_mul_i32 s62, s65, 4
  s_add_u32 s62, s62, s3
  s_add_u32 s62, s62, 2
  s_lshl_b32 s62, s62, 10
  s_add_u32 s62, s62, s60
  s_add_u32 s62, s62, 524288
  v_add_u32 v246, s62, v2
  s_mul_i32 s63, s64, 114688
  v_add_u32 v250, s63, v246
  s_xor_b32 s63, s64, 1
  s_mul_i32 s63, s63, 114688
  v_add_u32 v251, s63, v246
  s_lshl_b32 s62, s64, 5
  s_add_u32 s62, s62, s3
  s_lshl_b32 s62, s62, 10
  s_add_u32 s62, s62, s60
  s_add_u32 s62, s62, 262144
  v_add_u32 v252, s62, v2
  v_xor_b32 v253, 0x8000, v252
  s_lshl_b32 s63, s64, 7
  s_add_u32 s63, s63, 157696
  v_and_b32 v9, 31, v0
  v_lshl_add_u32 v9, v9, 2, s63
  v_lshlrev_b32 v254, 25, v0
  ds_read_b64_tr_b16 a[112:113], v10 offset:0
  ds_read_b64_tr_b16 a[114:115], v10 offset:2048
  ds_read_b64_tr_b16 a[116:117], v11 offset:0
  ds_read_b64_tr_b16 a[118:119], v11 offset:2048
  ds_read_b64_tr_b16 a[120:121], v10 offset:4096
  ds_read_b64_tr_b16 a[122:123], v10 offset:6144
  ds_read_b64_tr_b16 a[124:125], v11 offset:4096
  ds_read_b64_tr_b16 a[126:127], v11 offset:6144
  ds_read_b64_tr_b16 a[240:241], v10 offset:8192
  ds_read_b64_tr_b16 a[242:243], v10 offset:10240
  ds_read_b64_tr_b16 a[244:245], v11 offset:8192
  ds_read_b64_tr_b16 a[246:247], v11 offset:10240
  s_mov_b32 s68, 0
L_poll_15:
  buffer_load_dword v241, v240, s[48:51], s70 offen sc1
  s_add_u32 s68, s68, 1
  s_cmp_ge_u32 s68, 1048576
  s_cbranch_scc1 L_end
  s_waitcnt vmcnt(0)
  v_cmp_ne_u32 vcc, s6, v241
  s_nop 0
  s_cmp_lg_u64 vcc, 0
  s_cbranch_scc1 L_poll_15
  s_cmp_lg_u32 s7, 0
  s_cbranch_scc1 L_acq_16
L_acq_16r:
  buffer_load_dwordx4 v[96:99], v4, s[44:47], s73 offen sc1
  buffer_load_dwordx4 v[100:103], v5, s[44:47], s73 offen sc1
  buffer_load_dwordx4 v[104:107], v6, s[44:47], s73 offen sc1
  buffer_load_dwordx4 v[108:111], v7, s[44:47], s73 offen sc1
  s_add_u32 s73, s73, 4096
  buffer_load_dwordx4 v[112:115], v4, s[44:47], s73 offen sc1
  buffer_load_dwordx4 v[116:119], v5, s[44:47], s73 offen sc1
  s_waitcnt lgkmcnt(8) vmcnt(5)
  v_mfma_f32_32x32x16_bf16 v[208:223], a[112:115], v[96:99], 0
  buffer_load_dwordx4 v[120:123], v6, s[44:47], s73 offen sc1
  ds_read_b64_tr_b16 a[248:249], v10 offset:12288
  ds_read_b64_tr_b16 a[160:161], v14 offset:4096
  v_mfma_f32_32x32x16_bf16 v[224:239], a[116:119], v[96:99], 0
  ds_read_b64_tr_b16 a[250:251], v10 offset:14336
  ds_read_b64_tr_b16 a[252:253], v11 offset:12288
  ds_read_b64_tr_b16 a[254:255], v11 offset:14336
  ds_read_b64_tr_b16 a[162:163], v14 offset:5120
  ds_read_b64_tr_b16 a[164:165], v15 offset:4096
  ds_read_b64_tr_b16 a[166:167], v15 offset:5120
  s_waitcnt lgkmcnt(12) vmcnt(5)
  v_mfma_f32_32x32x16_bf16 v[208:223], a[120:123], v[100:103], v[208:223]
  buffer_load_dwordx4 v[124:127], v7, s[44:47], s73 offen sc1
  ds_read_b64_tr_b16 a[112:113], v10 offset:16384
  ds_read_b64_tr_b16 a[168:169], v14 offset:6144
  v_mfma_f32_32x32x16_bf16 v[224:239], a[124:127], v[100:103], v[224:239]
  ds_read_b64_tr_b16 a[114:115], v10 offset:18432
  ds_read_b64_tr_b16 a[116:117], v11 offset:16384
  ds_read_b64_tr_b16 a[118:119], v11 offset:18432
  ds_read_b64_tr_b16 a[170:171], v14 offset:7168
  ds_read_b64_tr_b16 a[172:173], v15 offset:6144
  ds_read_b64_tr_b16 a[174:175], v15 offset:7168
  s_waitcnt lgkmcnt(15) vmcnt(5)
  v_mfma_f32_32x32x16_bf16 v[208:223], a[240:243], v[104:107], v[208:223]
  s_add_u32 s73, s73, 4096
  buffer_load_dwordx4 v[128:131], v4, s[44:47], s73 offen sc1
  ds_read_b64_tr_b16 a[120:121], v10 offset:20480
  ds_read_b64_tr_b16 a[122:123], v10 offset:22528
  ds_read_b64_tr_b16 a[124:125], v11 offset:20480
  v_mfma_f32_32x32x16_bf16 v[224:239], a[244:247], v[104:107], v[224:239]
  s_mov_b32 m0, s74
  s_nop 0
  buffer_load_dwordx4 v2, s[48:51], s71 offen offset:0 sc1 lds
  ds_read_b64_tr_b16 a[126:127], v11 offset:22528
  s_waitcnt lgkmcnt(15) vmcnt(6)
  v_mfma_f32_32x32x16_bf16 v[208:223], a[248:251], v[108:111], v[208:223]
  buffer_load_dwordx4 v[132:135], v5, s[44:47], s73 offen sc1
  ds_read_b64_tr_b16 a[240:241], v10 offset:24576
  ds_read_b64_tr_b16 a[176:177], v14 offset:8192
  v_mfma_f32_32x32x16_bf16 v[224:239], a[252:255], v[108:111], v[224:239]
  ds_read_b64_tr_b16 a[242:243], v10 offset:26624
  ds_read_b64_tr_b16 a[244:245], v11 offset:24576
  ds_read_b64_tr_b16 a[246:247], v11 offset:26624
  ds_read_b64_tr_b16 a[178:179], v14 offset:9216
  ds_read_b64_tr_b16 a[180:181], v15 offset:8192
  ds_read_b64_tr_b16 a[182:183], v15 offset:9216
  s_waitcnt lgkmcnt(15) vmcnt(6)
  v_mfma_f32_32x32x16_bf16 v[208:223], a[112:115], v[112:115], v[208:223]
  buffer_load_dwordx4 v[136:139], v6, s[44:47], s73 offen sc1
  ds_read_b64_tr_b16 a[248:249], v10 offset:28672
  ds_read_b64_tr_b16 a[250:251], v10 offset:30720
  v_mfma_f32_32x32x16_bf16 v[224:239], a[116:119], v[112:115], v[224:239]
  buffer_load_dwordx4 v2, s[48:51], s71 offen offset:1024 sc1 lds
  ds_read_b64_tr_b16 a[252:253], v11 offset:28672
  ds_read_b64_tr_b16 a[254:255], v11 offset:30720
  s_waitcnt lgkmcnt(12) vmcnt(7)
  v_mfma_f32_32x32x16_bf16 v[208:223], a[120:123], v[116:119], v[208:223]
  buffer_load_dwordx4 v[140:143], v7, s[44:47], s73 offen sc1
  ds_read_b64_tr_b16 a[112:113], v10 offset:32768
  v_mfma_f32_32x32x16_bf16 v[224:239], a[124:127], v[116:119], v[224:239]
  ds_read_b64_tr_b16 a[114:115], v10 offset:34816
  ds_read_b64_tr_b16 a[116:117], v11 offset:32768
  ds_read_b64_tr_b16 a[118:119], v11 offset:34816
  s_waitcnt lgkmcnt(11) vmcnt(7)
  v_mfma_f32_32x32x16_bf16 v[208:223], a[240:243], v[120:123], v[208:223]
  s_add_u32 s73, s73, 4096
  buffer_load_dwordx4 v[144:147], v4, s[44:47], s73 offen sc1
  ds_read_b64_tr_b16 a[120:121], v10 offset:36864
  ds_read_b64_tr_b16 a[122:123], v10 offset:38912
  v_mfma_f32_32x32x16_bf16 v[224:239], a[244:247], v[120:123], v[224:239]
  buffer_load_dwordx4 v2, s[48:51], s71 offen offset:2048 sc1 lds
  ds_read_b64_tr_b16 a[124:125], v11 offset:36864
  ds_read_b64_tr_b16 a[126:127], v11 offset:38912
  s_waitcnt lgkmcnt(8) vmcnt(8)
  v_mfma_f32_32x32x16_bf16 v[208:223], a[248:251], v[124:127], v[208:223]
  buffer_load_dwordx4 v[148:151], v5, s[44:47], s73 offen sc1
  ds_read_b64_tr_b16 a[240:241], v10 offset:40960
  v_mfma_f32_32x32x16_bf16 v[224:239], a[252:255], v[124:127], v[224:239]
  ds_read_b64_tr_b16 a[242:243], v10 offset:43008
  ds_read_b64_tr_b16 a[244:245], v11 offset:40960
  ds_read_b64_tr_b16 a[246:247], v11 offset:43008
  s_waitcnt lgkmcnt(8) vmcnt(8)
  v_mfma_f32_32x32x16_bf16 v[208:223], a[112:115], v[128:131], v[208:223]
  buffer_load_dwordx4 v[152:155], v6, s[44:47], s73 offen sc1
  ds_read_b64_tr_b16 a[248:249], v10 offset:45056
  ds_read_b64_tr_b16 a[250:251], v10 offset:47104
  v_mfma_f32_32x32x16_bf16 v[224:239], a[116:119], v[128:131], v[224:239]
  buffer_load_dwordx4 v2, s[48:51], s71 offen offset:3072 sc1 lds
  ds_read_b64_tr_b16 a[252:253], v11 offset:45056
  ds_read_b64_tr_b16 a[254:255], v11 offset:47104
  s_waitcnt lgkmcnt(8) vmcnt(8)
  v_mfma_f32_32x32x16_bf16 v[208:223], a[120:123], v[132:135], v[208:223]
  buffer_load_dwordx4 v[156:159], v7, s[44:47], s73 offen sc1
  ds_read_b64_tr_b16 a[112:113], v10 offset:49152
  v_mfma_f32_32x32x16_bf16 v[224:239], a[124:127], v[132:135], v[224:239]
  ds_read_b64_tr_b16 a[114:115], v10 offset:51200
  ds_read_b64_tr_b16 a[116:117], v11 offset:49152
  ds_read_b64_tr_b16 a[118:119], v11 offset:51200
  s_waitcnt lgkmcnt(8) vmcnt(8)
  v_mfma_f32_32x32x16_bf16 v[208:223], a[240:243], v[136:139], v[208:223]
  s_add_u32 s73, s73, 4096
  buffer_load_dwordx4 v[160:163], v4, s[44:47], s73 offen sc1
  v_mfma_f32_32x32x16_bf16 v[224:239], a[244:247], v[136:139], v[224:239]
  ds_read_b64_tr_b16 a[120:121], v10 offset:53248
  ds_read_b64_tr_b16 a[122:123], v10 offset:55296
  ds_read_b64_tr_b16 a[124:125], v11 offset:53248
  ds_read_b64_tr_b16 a[126:127], v11 offset:55296
  s_waitcnt lgkmcnt(8) vmcnt(7)
  v_mfma_f32_32x32x16_bf16 v[208:223], a[248:251], v[140:143], v[208:223]
  buffer_load_dwordx4 v[164:167], v5, s[44:47], s73 offen sc1
  ds_read_b64_tr_b16 a[240:241], v88 offset:0
  v_mfma_f32_32x32x16_bf16 v[224:239], a[252:255], v[140:143], v[224:239]
  ds_read_b64_tr_b16 a[242:243], v88 offset:2048
  ds_read_b64_tr_b16 a[244:245], v89 offset:0
  ds_read_b64_tr_b16 a[246:247], v89 offset:2048
  s_waitcnt lgkmcnt(8) vmcnt(7)
  v_mfma_f32_32x32x16_bf16 v[208:223], a[112:115], v[144:147], v[208:223]
  buffer_load_dwordx4 v[168:171], v6, s[44:47], s73 offen sc1
  ds_read_b64_tr_b16 a[248:249], v88 offset:4096
  v_mfma_f32_32x32x16_bf16 v[224:239], a[116:119], v[144:147], v[224:239]
  ds_read_b64_tr_b16 a[250:251], v88 offset:6144
  ds_read_b64_tr_b16 a[252:253], v89 offset:4096
  ds_read_b64_tr_b16 a[254:255], v89 offset:6144
  s_waitcnt lgkmcnt(8) vmcnt(6)
  v_mfma_f32_32x32x16_bf16 v[208:223], a[120:123], v[148:151], v[208:223]
  buffer_load_dwordx4 v[172:175], v7, s[44:47], s73 offen sc1
  ds_read_b64_tr_b16 a[112:113], v88 offset:8192
  v_mfma_f32_32x32x16_bf16 v[224:239], a[124:127], v[148:151], v[224:239]
  ds_read_b64_tr_b16 a[114:115], v88 offset:10240
  ds_read_b64_tr_b16 a[116:117], v89 offset:8192
  ds_read_b64_tr_b16 a[118:119], v89 offset:10240
  s_waitcnt vmcnt(5)
  ds_read2st64_b32 v[32:33], v242 offset0:0 offset1:1
  ds_read2st64_b32 v[34:35], v242 offset0:2 offset1:3
  s_waitcnt lgkmcnt(10)
  v_mfma_f32_32x32x16_bf16 v[208:223], a[240:243], v[152:155], v[208:223]
  s_add_u32 s73, s73, 4096
  buffer_load_dwordx4 v[176:179], v4, s[44:47], s73 offen sc1
  ds_read2st64_b32 v[36:37], v242 offset0:4 offset1:5
  ds_read2st64_b32 v[38:39], v242 offset0:6 offset1:7
  v_mfma_f32_32x32x16_bf16 v[224:239], a[244:247], v[152:155], v[224:239]
  ds_read_b64_tr_b16 a[120:121], v88 offset:12288
  ds_read_b64_tr_b16 a[122:123], v88 offset:14336
  ds_read_b64_tr_b16 a[124:125], v89 offset:12288
  ds_read_b64_tr_b16 a[126:127], v89 offset:14336
  ds_read2st64_b32 v[40:41], v242 offset0:8 offset1:9
  ds_read2st64_b32 v[42:43], v242 offset0:10 offset1:11
  s_waitcnt lgkmcnt(14) vmcnt(5)
  v_mfma_f32_32x32x16_bf16 v[208:223], a[248:251], v[156:159], v[208:223]
  buffer_load_dwordx4 v[180:183], v5, s[44:47], s73 offen sc1
  ds_read_b64_tr_b16 a[240:241], v88 offset:16384
  ds_read2st64_b32 v[44:45], v242 offset0:12 offset1:13
  v_mfma_f32_32x32x16_bf16 v[224:239], a[252:255], v[156:159], v[224:239]
  ds_read_b64_tr_b16 a[242:243], v88 offset:18432
  ds_read_b64_tr_b16 a[244:245], v89 offset:16384
  ds_read_b64_tr_b16 a[246:247], v89 offset:18432
  s_waitcnt lgkmcnt(15) vmcnt(5)
  v_mfma_f32_32x32x16_bf16 v[208:223], a[112:115], v[160:163], v[208:223]
  buffer_load_dwordx4 v[184:187], v6, s[44:47], s73 offen sc1
  ds_read_b64_tr_b16 a[248:249], v88 offset:20480
  ds_read_b64_tr_b16 a[250:251], v88 offset:22528
  s_waitcnt lgkmcnt(13)
  v_add_f32 v32, v32, v39
  s_waitcnt lgkmcnt(8)
  v_add_f32 v33, v33, v40
  v_add_f32 v34, v34, v41
  v_mfma_f32_32x32x16_bf16 v[224:239], a[116:119], v[160:163], v[224:239]
  buffer_load_dwordx2 v[16:17], v245, s[48:51], s56 offen offset:0 sc1
  ds_read_b64_tr_b16 a[252:253], v89 offset:20480
  ds_read_b64_tr_b16 a[254:255], v89 offset:22528
  s_waitcnt lgkmcnt(9)
  v_add_f32 v35, v35, v42
  v_add_f32 v36, v36, v43
  s_waitcnt vmcnt(6)
  v_mfma_f32_32x32x16_bf16 v[208:223], a[120:123], v[164:167], v[208:223]
  buffer_load_dwordx4 v[188:191], v7, s[44:47], s73 offen sc1
  ds_read_b64_tr_b16 a[112:113], v88 offset:24576
  ds_read_b64_tr_b16 a[114:115], v88 offset:26624
  s_waitcnt lgkmcnt(9)
  v_add_f32 v37, v37, v44
  v_add_f32 v38, v38, v45
  v_add_f32 v32, v32, v33
  v_mfma_f32_32x32x16_bf16 v[224:239], a[124:127], v[164:167], v[224:239]
  buffer_load_dwordx2 v[18:19], v245, s[48:51], s56 offen offset:512 sc1
  ds_read_b64_tr_b16 a[116:117], v89 offset:24576
  ds_read_b64_tr_b16 a[118:119], v89 offset:26624
  v_add_f32 v34, v34, v35
  v_add_f32 v36, v36, v37
  s_waitcnt lgkmcnt(8) vmcnt(7)
  v_mfma_f32_32x32x16_bf16 v[208:223], a[240:243], v[168:171], v[208:223]
  s_add_u32 s73, s73, 4096
  buffer_load_dwordx4 v[192:195], v4, s[44:47], s73 offen sc1
  ds_read_b64_tr_b16 a[120:121], v88 offset:28672
  ds_read_b64_tr_b16 a[122:123], v88 offset:30720
  v_add_f32 v32, v32, v34
  v_add_f32 v36, v36, v38
  v_mfma_f32_32x32x16_bf16 v[224:239], a[244:247], v[168:171], v[224:239]
  buffer_load_dwordx2 v[20:21], v245, s[48:51], s56 offen offset:1024 sc1
  ds_read_b64_tr_b16 a[124:125], v89 offset:28672
  ds_read_b64_tr_b16 a[126:127], v89 offset:30720
  v_add_f32 v32, v32, v36
  v_mul_f32 v32, 0x3b124925, v32
  s_waitcnt lgkmcnt(8) vmcnt(8)
  v_mfma_f32_32x32x16_bf16 v[208:223], a[248:251], v[172:175], v[208:223]
  buffer_load_dwordx4 v[196:199], v5, s[44:47], s73 offen sc1
  ds_read_b64_tr_b16 a[240:241], v88 offset:32768
  ds_read_b64_tr_b16 a[242:243], v88 offset:34816
  v_mov_b32 v33, v32
  s_lshl_b32 s63, s3, 7
  s_add_u32 s63, s63, 157696
  v_mfma_f32_32x32x16_bf16 v[224:239], a[252:255], v[172:175], v[224:239]
  buffer_load_dwordx2 v[22:23], v245, s[48:51], s56 offen offset:1536 sc1
  ds_read_b64_tr_b16 a[244:245], v89 offset:32768
  ds_read_b64_tr_b16 a[246:247], v89 offset:34816
  v_permlane32_swap_b32 v32, v33
  v_fma_f32 v33, -v32, v32, v33
  s_waitcnt lgkmcnt(8) vmcnt(9)
  v_mfma_f32_32x32x16_bf16 v[208:223], a[112:115], v[176:179], v[208:223]
  buffer_load_dwordx4 v[200:203], v6, s[44:47], s73 offen sc1
  ds_read_b64_tr_b16 a[248:249], v88 offset:36864
  v_max_f32 v33, 0, v33
  v_add_f32 v33, 0x3727c5ac, v33
  v_rcp_f32 v34, v33
  v_mfma_f32_32x32x16_bf16 v[224:239], a[116:119], v[176:179], v[224:239]
  ds_read_b64_tr_b16 a[250:251], v88 offset:38912
  ds_read_b64_tr_b16 a[252:253], v89 offset:36864
  ds_read_b64_tr_b16 a[254:255], v89 offset:38912
  v_sqrt_f32 v33, v33
  v_xor_b32 v32, 0x80000000, v32
  v_cmp_lt_u32 vcc, 31, v0
  v_and_b32 v35, 31, v0
  s_waitcnt lgkmcnt(8) vmcnt(9)
  v_mfma_f32_32x32x16_bf16 v[208:223], a[120:123], v[180:183], v[208:223]
  buffer_load_dwordx4 v[204:207], v7, s[44:47], s73 offen sc1
  ds_read_b64_tr_b16 a[112:113], v88 offset:40960
  v_lshl_add_u32 v35, v35, 2, s63
  v_cndmask_b32 v32, v32, v33, vcc
  ds_write_b32 v35, v34
  v_cvt_pk_bf16_f32 v92, v32, v32
  v_mfma_f32_32x32x16_bf16 v[224:239], a[124:127], v[180:183], v[224:239]
  ds_read_b64_tr_b16 a[114:115], v88 offset:43008
  ds_read_b64_tr_b16 a[116:117], v89 offset:40960
  ds_read_b64_tr_b16 a[118:119], v89 offset:43008
  v_and_b32 v33, 0xffff0000, v92
  v_sub_f32 v33, v32, v33
  v_cvt_pk_bf16_f32 v93, v33, v33
  v_mov_b32 v94, 0
  v_mov_b32 v95, 0
  s_waitcnt lgkmcnt(9) vmcnt(9)
  v_mfma_f32_32x32x16_bf16 v[208:223], a[240:243], v[184:187], v[208:223]
  s_mul_i32 s61, s36, 14
  s_add_u32 m0, s74, 4096
  s_add_u32 s77, s77, 28672
  s_add_u32 s61, s61, s77
  buffer_load_dwordx4 v1, s[28:31], s61 offen  lds
  v_mfma_f32_32x32x16_bf16 v[224:239], a[244:247], v[184:187], v[224:239]
  buffer_load_dwordx4 v255, s[28:31], s61 offen offset:1024  lds
  ds_read_b64_tr_b16 a[120:121], v88 offset:45056
  ds_read_b64_tr_b16 a[122:123], v88 offset:47104
  ds_read_b64_tr_b16 a[124:125], v89 offset:45056
  ds_read_b64_tr_b16 a[126:127], v89 offset:47104
  s_waitcnt lgkmcnt(9) vmcnt(9)
  v_mfma_f32_32x32x16_bf16 v[208:223], a[248:251], v[188:191], v[208:223]
  ds_read_b64_tr_b16 a[240:241], v88 offset:49152
  ds_read_b64_tr_b16 a[242:243], v88 offset:51200
  v_xor_b32 v246, s6, v17
  s_waitcnt vmcnt(8)
  v_xor_b32 v247, s6, v19
  v_or_b32 v246, v246, v247
  v_mfma_f32_32x32x16_bf16 v[224:239], a[252:255], v[188:191], v[224:239]
  ds_read_b64_tr_b16 a[244:245], v89 offset:49152
  ds_read_b64_tr_b16 a[246:247], v89 offset:51200
  s_waitcnt vmcnt(6)
  v_xor_b32 v247, s6, v21
  v_or_b32 v246, v246, v247
  s_waitcnt lgkmcnt(8)
  v_mfma_f32_32x32x16_bf16 v[208:223], a[112:115], v[192:195], v[208:223]
  ds_read_b64_tr_b16 a[248:249], v88 offset:53248
  ds_read_b64_tr_b16 a[250:251], v88 offset:55296
  s_waitcnt vmcnt(4)
  v_xor_b32 v247, s6, v23
  v_or_b32 v246, v246, v247
  v_cmp_ne_u32 vcc, 0, v246
  v_mfma_f32_32x32x16_bf16 v[224:239], a[116:119], v[192:195], v[224:239]
  ds_read_b64_tr_b16 a[252:253], v89 offset:53248
  ds_read_b64_tr_b16 a[254:255], v89 offset:55296
  s_cmp_lg_u64 vcc, 0
  s_cbranch_scc1 L_chk_25
L_chk_25r:
  s_waitcnt lgkmcnt(8)
  v_mfma_f32_32x32x16_bf16 v[208:223], a[120:123], v[196:199], v[208:223]
  s_mul_i32 s61, s37, 14
  s_add_u32 m0, s74, 6144
  s_add_u32 s61, s61, s77
  buffer_load_dwordx4 v1, s[28:31], s61 offen  lds
  v_accvgpr_write_b32 a112, v16
  v_mfma_f32_32x32x16_bf16 v[224:239], a[124:127], v[196:199], v[224:239]
  buffer_load_dwordx4 v255, s[28:31], s61 offen offset:1024  lds
  v_accvgpr_write_b32 a113, v16
  v_accvgpr_write_b32 a116, v18
  v_accvgpr_write_b32 a117, v18
  s_waitcnt lgkmcnt(4) vmcnt(5)
  v_mfma_f32_32x32x16_bf16 v[208:223], a[240:243], v[200:203], v[208:223]
  ds_read_b64_tr_b16 a[120:121], v12 offset:0
  ds_read_b64_tr_b16 a[122:123], v12 offset:2048
  v_mfma_f32_32x32x16_bf16 v[224:239], a[244:247], v[200:203], v[224:239]
  ds_read_b64_tr_b16 a[124:125], v12 offset:4096
  ds_read_b64_tr_b16 a[126:127], v12 offset:6144
  s_waitcnt lgkmcnt(4) vmcnt(4)
  v_mfma_f32_32x32x16_bf16 v[208:223], a[248:251], v[204:207], v[208:223]
  ds_read_b64_tr_b16 a[240:241], v12 offset:8192
  ds_read_b64_tr_b16 a[242:243], v12 offset:10240
  v_mfma_f32_32x32x16_bf16 v[224:239], a[252:255], v[204:207], v[224:239]
  ds_read_b64_tr_b16 a[244:245], v12 offset:12288
  ds_read_b64_tr_b16 a[246:247], v12 offset:14336
  v_mfma_f32_32x32x16_bf16 v[208:223], a[112:115], v[92:95], v[208:223]
  s_mul_i32 s61, s38, 14
  s_add_u32 m0, s74, 8192
  s_add_u32 s61, s61, s77
  buffer_load_dwordx4 v1, s[28:31], s61 offen  lds
  ds_read_b64_tr_b16 a[248:249], v12 offset:16384
  v_mfma_f32_32x32x16_bf16 v[224:239], a[116:119], v[92:95], v[224:239]
  buffer_load_dwordx4 v255, s[28:31], s61 offen offset:1024  lds
  ds_read_b64_tr_b16 a[250:251], v12 offset:18432
  ds_read_b64_tr_b16 a[252:253], v12 offset:20480
  ds_read_b64_tr_b16 a[254:255], v12 offset:22528
  s_waitcnt lgkmcnt(8)
  v_mfma_f32_32x32x16_bf16 v[32:47], a[120:123], v[96:99], 0
  ds_read_b64_tr_b16 a[112:113], v12 offset:24576
  ds_read_b64_tr_b16 a[114:115], v12 offset:26624
  v_mfma_f32_32x32x16_bf16 v[32:47], a[124:127], v[100:103], v[32:47]
  ds_read_b64_tr_b16 a[116:117], v12 offset:28672
  ds_read_b64_tr_b16 a[118:119], v12 offset:30720
  s_waitcnt lgkmcnt(8)
  v_mfma_f32_32x32x16_bf16 v[32:47], a[240:243], v[104:107], v[32:47]
  s_mul_i32 s61, s39, 14
  s_add_u32 m0, s74, 0
  s_add_u32 s61, s61, s77
  buffer_load_dwordx4 v1, s[28:31], s61 offen  lds
  ds_read_b64_tr_b16 a[120:121], v12 offset:32768
  v_mfma_f32_32x32x16_bf16 v[32:47], a[244:247], v[108:111], v[32:47]
  buffer_load_dwordx4 v255, s[28:31], s61 offen offset:1024  lds
  ds_read_b64_tr_b16 a[122:123], v12 offset:34816
  ds_read_b64_tr_b16 a[124:125], v12 offset:36864
  ds_read_b64_tr_b16 a[126:127], v12 offset:38912
  v_max_f32 v208, 0, v208
  v_max_f32 v209, 0, v209
  v_max_f32 v210, 0, v210
  v_max_f32 v211, 0, v211
  s_waitcnt lgkmcnt(8)
  v_mfma_f32_32x32x16_bf16 v[32:47], a[248:251], v[112:115], v[32:47]
  ds_read_b64_tr_b16 a[240:241], v12 offset:40960
  ds_read_b64_tr_b16 a[242:243], v12 offset:43008
  v_max_f32 v212, 0, v212
  v_max_f32 v213, 0, v213
  v_max_f32 v214, 0, v214
  v_max_f32 v215, 0, v215
  v_mul_f32 v208, v208, v208
  v_mul_f32 v209, v209, v209
  v_mul_f32 v210, v210, v210
  v_mul_f32 v211, v211, v211
  v_mul_f32 v212, v212, v212
  v_mul_f32 v213, v213, v213
  s_waitcnt vmcnt(6)
  ds_read_b64_tr_b16 a[184:185], v14 offset:4096
  v_mfma_f32_32x32x16_bf16 v[32:47], a[252:255], v[116:119], v[32:47]
  ds_read_b64_tr_b16 a[244:245], v12 offset:45056
  ds_read_b64_tr_b16 a[246:247], v12 offset:47104
  v_mul_f32 v214, v214, v214
  v_mul_f32 v215, v215, v215
  v_cvt_pk_bf16_f32 v208, v208, v209
  v_cvt_pk_bf16_f32 v209, v210, v211
  v_cvt_pk_bf16_f32 v210, v212, v213
  v_cvt_pk_bf16_f32 v211, v214, v215
  buffer_store_dwordx4 v[208:211], v2, s[48:51], s75 offen offset:0 sc1
  ds_read_b64_tr_b16 a[186:187], v14 offset:5120
  s_waitcnt lgkmcnt(10)
  v_mfma_f32_32x32x16_bf16 v[32:47], a[112:115], v[120:123], v[32:47]
  ds_read_b64_tr_b16 a[248:249], v12 offset:49152
  ds_read_b64_tr_b16 a[250:251], v12 offset:51200
  v_max_f32 v216, 0, v216
  v_max_f32 v217, 0, v217
  v_max_f32 v218, 0, v218
  v_max_f32 v219, 0, v219
  v_max_f32 v220, 0, v220
  v_max_f32 v221, 0, v221
  v_max_f32 v222, 0, v222
  v_max_f32 v223, 0, v223
  v_mul_f32 v216, v216, v216
  v_mul_f32 v217, v217, v217
  ds_read_b64_tr_b16 a[188:189], v15 offset:4096
  v_mfma_f32_32x32x16_bf16 v[32:47], a[116:119], v[124:127], v[32:47]
  ds_read_b64_tr_b16 a[252:253], v12 offset:53248
  ds_read_b64_tr_b16 a[254:255], v12 offset:55296
  v_mul_f32 v218, v218, v218
  v_mul_f32 v219, v219, v219
  v_mul_f32 v220, v220, v220
  v_mul_f32 v221, v221, v221
  v_mul_f32 v222, v222, v222
  v_mul_f32 v223, v223, v223
  v_cvt_pk_bf16_f32 v216, v216, v217
  v_cvt_pk_bf16_f32 v217, v218, v219
  v_cvt_pk_bf16_f32 v218, v220, v221
  ds_read_b64_tr_b16 a[190:191], v15 offset:5120
  s_waitcnt lgkmcnt(12)
  v_mfma_f32_32x32x16_bf16 v[32:47], a[120:123], v[128:131], v[32:47]
  s_mul_i32 s61, s40, 14
  s_add_u32 m0, s74, 2048
  s_add_u32 s61, s61, s77
  buffer_load_dwordx4 v1, s[28:31], s61 offen  lds
  ds_read_b64_tr_b16 a[112:113], v90 offset:0
  v_cvt_pk_bf16_f32 v219, v222, v223
  buffer_store_dwordx4 v[216:219], v2, s[48:51], s75 offen offset:1024 sc1
  v_mfma_f32_32x32x16_bf16 v[32:47], a[124:127], v[132:135], v[32:47]
  buffer_load_dwordx4 v255, s[28:31], s61 offen offset:1024  lds
  ds_read_b64_tr_b16 a[114:115], v90 offset:2048
  ds_read_b64_tr_b16 a[116:117], v90 offset:4096
  ds_read_b64_tr_b16 a[118:119], v90 offset:6144
  s_waitcnt vmcnt(8)
  ds_read_b64_tr_b16 a[192:193], v14 offset:6144
  ds_read_b64_tr_b16 a[194:195], v14 offset:7168
  ds_read_b64_tr_b16 a[196:197], v15 offset:6144
  s_waitcnt lgkmcnt(14)
  v_mfma_f32_32x32x16_bf16 v[32:47], a[240:243], v[136:139], v[32:47]
  ds_read_b64_tr_b16 a[120:121], v90 offset:8192
  ds_read_b64_tr_b16 a[122:123], v90 offset:10240
  s_xor_b32 s75, s75, 2048
  v_max_f32 v224, 0, v224
  v_max_f32 v225, 0, v225
  v_max_f32 v226, 0, v226
  v_max_f32 v227, 0, v227
  v_max_f32 v228, 0, v228
  v_max_f32 v229, 0, v229
  v_max_f32 v230, 0, v230
  v_max_f32 v231, 0, v231
  v_mfma_f32_32x32x16_bf16 v[32:47], a[244:247], v[140:143], v[32:47]
  ds_read_b64_tr_b16 a[124:125], v90 offset:12288
  ds_read_b64_tr_b16 a[126:127], v90 offset:14336
  v_mul_f32 v224, v224, v224
  v_mul_f32 v225, v225, v225
  v_mul_f32 v226, v226, v226
  v_mul_f32 v227, v227, v227
  v_mul_f32 v228, v228, v228
  v_mul_f32 v229, v229, v229
  v_mul_f32 v230, v230, v230
  v_mul_f32 v231, v231, v231
  s_waitcnt lgkmcnt(12)
  v_mfma_f32_32x32x16_bf16 v[32:47], a[248:251], v[144:147], v[32:47]
  ds_read_b64_tr_b16 a[240:241], v90 offset:16384
  ds_read_b64_tr_b16 a[242:243], v90 offset:18432
  v_cvt_pk_bf16_f32 v224, v224, v225
  v_cvt_pk_bf16_f32 v225, v226, v227
  v_cvt_pk_bf16_f32 v226, v228, v229
  v_cvt_pk_bf16_f32 v227, v230, v231
  buffer_store_dwordx4 v[224:227], v2, s[48:51], s75 offen offset:0 sc1
  v_max_f32 v232, 0, v232
  ds_read_b64_tr_b16 a[198:199], v15 offset:7168
  v_mfma_f32_32x32x16_bf16 v[32:47], a[252:255], v[148:151], v[32:47]
  ds_read_b64_tr_b16 a[244:245], v90 offset:20480
  ds_read_b64_tr_b16 a[246:247], v90 offset:22528
  v_max_f32 v233, 0, v233
  v_max_f32 v234, 0, v234
  v_max_f32 v235, 0, v235
  v_max_f32 v236, 0, v236
  v_max_f32 v237, 0, v237
  v_max_f32 v238, 0, v238
  v_max_f32 v239, 0, v239
  v_mul_f32 v232, v232, v232
  s_waitcnt lgkmcnt(12)
  v_mfma_f32_32x32x16_bf16 v[32:47], a[112:115], v[152:155], v[32:47]
  s_mul_i32 s61, s41, 14
  s_add_u32 m0, s74, 4096
  s_add_u32 s61, s61, s77
  buffer_load_dwordx4 v1, s[28:31], s61 offen  lds
  ds_read_b64_tr_b16 a[248:249], v90 offset:24576
  v_mul_f32 v233, v233, v233
  v_mul_f32 v234, v234, v234
  v_mfma_f32_32x32x16_bf16 v[32:47], a[116:119], v[156:159], v[32:47]
  buffer_load_dwordx4 v255, s[28:31], s61 offen offset:1024  lds
  ds_read_b64_tr_b16 a[250:251], v90 offset:26624
  ds_read_b64_tr_b16 a[252:253], v90 offset:28672
  ds_read_b64_tr_b16 a[254:255], v90 offset:30720
  v_mul_f32 v235, v235, v235
  v_mul_f32 v236, v236, v236
  v_mul_f32 v237, v237, v237
  s_waitcnt lgkmcnt(9)
  v_mfma_f32_32x32x16_bf16 v[32:47], a[120:123], v[160:163], v[32:47]
  ds_read_b64_tr_b16 a[112:113], v90 offset:32768
  ds_read_b64_tr_b16 a[114:115], v90 offset:34816
  v_mul_f32 v238, v238, v238
  v_mul_f32 v239, v239, v239
  v_cvt_pk_bf16_f32 v232, v232, v233
  v_cvt_pk_bf16_f32 v233, v234, v235
  v_cvt_pk_bf16_f32 v234, v236, v237
  v_cvt_pk_bf16_f32 v235, v238, v239
  buffer_store_dwordx4 v[232:235], v2, s[48:51], s75 offen offset:1024 sc1
  v_mfma_f32_32x32x16_bf16 v[32:47], a[124:127], v[164:167], v[32:47]
  ds_read_b64_tr_b16 a[116:117], v90 offset:36864
  ds_read_b64_tr_b16 a[118:119], v90 offset:38912
  s_waitcnt vmcnt(10)
  ds_read_b64_tr_b16 a[200:201], v14 offset:8192
  s_waitcnt lgkmcnt(9)
  v_mfma_f32_32x32x16_bf16 v[32:47], a[240:243], v[168:171], v[32:47]
  ds_read_b64_tr_b16 a[120:121], v90 offset:40960
  ds_read_b64_tr_b16 a[122:123], v90 offset:43008
  ds_read_b64_tr_b16 a[202:203], v14 offset:9216
  ds_read_b64_tr_b16 a[204:205], v15 offset:8192
  ds_read_b64_tr_b16 a[206:207], v15 offset:9216
  v_mfma_f32_32x32x16_bf16 v[32:47], a[244:247], v[172:175], v[32:47]
  ds_read_b64_tr_b16 a[124:125], v90 offset:45056
  ds_read_b64_tr_b16 a[126:127], v90 offset:47104
  s_waitcnt lgkmcnt(12)
  v_mfma_f32_32x32x16_bf16 v[32:47], a[248:251], v[176:179], v[32:47]
  s_mul_i32 s61, s42, 14
  s_add_u32 m0, s74, 6144
  s_add_u32 s61, s61, s77
  buffer_load_dwordx4 v1, s[28:31], s61 offen  lds
  ds_read_b64_tr_b16 a[240:241], v90 offset:49152
  v_mfma_f32_32x32x16_bf16 v[32:47], a[252:255], v[180:183], v[32:47]
  buffer_load_dwordx4 v255, s[28:31], s61 offen offset:1024  lds
  ds_read_b64_tr_b16 a[242:243], v90 offset:51200
  ds_read_b64_tr_b16 a[244:245], v90 offset:53248
  ds_read_b64_tr_b16 a[246:247], v90 offset:55296
  s_waitcnt lgkmcnt(12)
  v_mfma_f32_32x32x16_bf16 v[32:47], a[112:115], v[184:187], v[32:47]
  v_accvgpr_write_b32 a248, v20
  v_accvgpr_write_b32 a249, v20
  s_waitcnt vmcnt(10)
  ds_read_b64_tr_b16 a[208:209], v14 offset:0
  ds_read_b64_tr_b16 a[210:211], v14 offset:1024
  v_mfma_f32_32x32x16_bf16 v[32:47], a[116:119], v[188:191], v[32:47]
  ds_read_b64_tr_b16 a[252:253], v13 offset:0
  ds_read_b64_tr_b16 a[254:255], v13 offset:2048
  ds_read_b64_tr_b16 a[212:213], v15 offset:0
  ds_read_b64_tr_b16 a[214:215], v15 offset:1024
  s_waitcnt lgkmcnt(10)
  v_mfma_f32_32x32x16_bf16 v[32:47], a[120:123], v[192:195], v[32:47]
  s_mul_i32 s61, s36, 14
  s_add_u32 m0, s74, 8192
  s_add_u32 s77, s77, 28672
  s_add_u32 s61, s61, s77
  buffer_load_dwordx4 v1, s[28:31], s61 offen  lds
  v_mfma_f32_32x32x16_bf16 v[32:47], a[124:127], v[196:199], v[32:47]
  buffer_load_dwordx4 v255, s[28:31], s61 offen offset:1024  lds
  ds_read_b64_tr_b16 a[112:113], v13 offset:4096
  ds_read_b64_tr_b16 a[114:115], v13 offset:6144
  ds_read_b64_tr_b16 a[116:117], v13 offset:8192
  ds_read_b64_tr_b16 a[118:119], v13 offset:10240
  s_waitcnt lgkmcnt(10)
  v_mfma_f32_32x32x16_bf16 v[32:47], a[240:243], v[200:203], v[32:47]
  ds_read_b64_tr_b16 a[120:121], v13 offset:12288
  ds_read_b64_tr_b16 a[122:123], v13 offset:14336
  s_waitcnt vmcnt(8)
  ds_read_b64_tr_b16 a[216:217], v14 offset:2048
  v_mfma_f32_32x32x16_bf16 v[32:47], a[244:247], v[204:207], v[32:47]
  ds_read_b64_tr_b16 a[124:125], v13 offset:16384
  ds_read_b64_tr_b16 a[126:127], v13 offset:18432
  ds_read_b64_tr_b16 a[218:219], v14 offset:3072
  s_waitcnt lgkmcnt(12)
  v_mfma_f32_32x32x16_bf16 v[32:47], a[248:251], v[92:95], v[32:47]
  ds_read_b64_tr_b16 a[240:241], v13 offset:20480
  ds_read_b64_tr_b16 a[242:243], v13 offset:22528
  ds_read_b64_tr_b16 a[220:221], v15 offset:2048
  ds_read_b64_tr_b16 a[222:223], v15 offset:3072
  v_mfma_f32_32x32x16_bf16 v[48:63], a[252:255], v[96:99], 0
  ds_read_b64_tr_b16 a[244:245], v13 offset:24576
  ds_read_b64_tr_b16 a[246:247], v13 offset:26624
  s_waitcnt lgkmcnt(12)
  v_mfma_f32_32x32x16_bf16 v[48:63], a[112:115], v[100:103], v[48:63]
  s_cmp_lg_u32 s7, 0
  s_cbranch_scc1 L_rel_17
  buffer_store_dword v3, v254, s[48:51], s8 offen offset:0
L_rel_17r:
  v_mfma_f32_32x32x16_bf16 v[48:63], a[116:119], v[104:107], v[48:63]
  ds_read_b64_tr_b16 a[248:249], v13 offset:28672
  ds_read_b64_tr_b16 a[250:251], v13 offset:30720
  ds_read_b64_tr_b16 a[252:253], v13 offset:32768
  ds_read_b64_tr_b16 a[254:255], v13 offset:34816
  s_waitcnt vmcnt(6)
  ds_read_b64_tr_b16 a[224:225], v14 offset:4096
  ds_read_b64_tr_b16 a[226:227], v14 offset:5120
  ds_read_b64_tr_b16 a[228:229], v15 offset:4096
  ds_read_b64_tr_b16 a[230:231], v15 offset:5120
  s_waitcnt lgkmcnt(15)
  v_mfma_f32_32x32x16_bf16 v[48:63], a[120:123], v[108:111], v[48:63]
  s_mul_i32 s61, s37, 14
  s_add_u32 m0, s74, 0
  s_add_u32 s61, s61, s77
  buffer_load_dwordx4 v1, s[28:31], s61 offen  lds
  ds_read_b64_tr_b16 a[112:113], v13 offset:36864
  s_add_u32 s75, s75, 4096
  s_xor_b32 s75, s75, 2048
  v_max_f32 v32, 0, v32
  v_max_f32 v33, 0, v33
  v_max_f32 v34, 0, v34
  v_max_f32 v35, 0, v35
  v_mfma_f32_32x32x16_bf16 v[48:63], a[124:127], v[112:115], v[48:63]
  buffer_load_dwordx4 v255, s[28:31], s61 offen offset:1024  lds
  ds_read_b64_tr_b16 a[114:115], v13 offset:38912
  ds_read_b64_tr_b16 a[116:117], v13 offset:40960
  ds_read_b64_tr_b16 a[118:119], v13 offset:43008
  v_max_f32 v36, 0, v36
  v_max_f32 v37, 0, v37
  v_max_f32 v38, 0, v38
  v_max_f32 v39, 0, v39
  v_mul_f32 v32, v32, v32
  v_mul_f32 v33, v33, v33
  v_mul_f32 v34, v34, v34
  s_waitcnt lgkmcnt(12)
  v_mfma_f32_32x32x16_bf16 v[48:63], a[240:243], v[116:119], v[48:63]
  buffer_load_dword v241, v249, s[48:51], s10 offen offset:0 sc1
  ds_read_b64_tr_b16 a[120:121], v13 offset:45056
  v_mul_f32 v35, v35, v35
  v_mul_f32 v36, v36, v36
  v_mul_f32 v37, v37, v37
  v_mul_f32 v38, v38, v38
  v_mul_f32 v39, v39, v39
  v_cvt_pk_bf16_f32 v32, v32, v33
  v_cvt_pk_bf16_f32 v33, v34, v35
  v_cvt_pk_bf16_f32 v34, v36, v37
  v_cvt_pk_bf16_f32 v35, v38, v39
  v_mfma_f32_32x32x16_bf16 v[48:63], a[244:247], v[120:123], v[48:63]
  ds_read_b64_tr_b16 a[122:123], v13 offset:47104
  ds_read_b64_tr_b16 a[124:125], v13 offset:49152
  ds_read_b64_tr_b16 a[126:127], v13 offset:51200
  buffer_store_dwordx4 v[32:35], v2, s[48:51], s75 offen offset:0 sc1
  v_max_f32 v40, 0, v40
  v_max_f32 v41, 0, v41
  v_max_f32 v42, 0, v42
  v_max_f32 v43, 0, v43
  v_max_f32 v44, 0, v44
  v_max_f32 v45, 0, v45
  v_max_f32 v46, 0, v46
  s_waitcnt lgkmcnt(12)
  v_mfma_f32_32x32x16_bf16 v[48:63], a[248:251], v[124:127], v[48:63]
  s_mul_i32 s61, s38, 14
  s_add_u32 m0, s74, 2048
  s_add_u32 s61, s61, s77
  buffer_load_dwordx4 v1, s[28:31], s61 offen  lds
  ds_read_b64_tr_b16 a[240:241], v13 offset:53248
  ds_read_b64_tr_b16 a[242:243], v13 offset:55296
  v_max_f32 v47, 0, v47
  v_mul_f32 v40, v40, v40
  v_mul_f32 v41, v41, v41
  v_mul_f32 v42, v42, v42
  v_mul_f32 v43, v43, v43
  v_mfma_f32_32x32x16_bf16 v[48:63], a[252:255], v[128:131], v[48:63]
  s_cmp_lg_u32 s7, 0
  s_waitcnt vmcnt(10)
  s_cbranch_scc1 L_rel_19
  buffer_store_dword v3, v254, s[48:51], s8 offen offset:256
L_rel_19r:
  ds_read_b64_tr_b16 a[244:245], v91 offset:0
  ds_read_b64_tr_b16 a[246:247], v91 offset:2048
  v_mul_f32 v44, v44, v44
  v_mul_f32 v45, v45, v45
  v_mul_f32 v46, v46, v46
  v_mul_f32 v47, v47, v47
  v_cvt_pk_bf16_f32 v40, v40, v41
  s_waitcnt lgkmcnt(8)
  v_mfma_f32_32x32x16_bf16 v[48:63], a[112:115], v[132:135], v[48:63]
  buffer_load_dwordx4 v255, s[28:31], s61 offen offset:1024  lds
  ds_read_b64_tr_b16 a[248:249], v91 offset:4096
  v_cvt_pk_bf16_f32 v41, v42, v43
  v_cvt_pk_bf16_f32 v42, v44, v45
  v_cvt_pk_bf16_f32 v43, v46, v47
  buffer_store_dwordx4 v[40:43], v2, s[48:51], s75 offen offset:1024 sc1
  v_mfma_f32_32x32x16_bf16 v[48:63], a[116:119], v[136:139], v[48:63]
  ds_read_b64_tr_b16 a[250:251], v91 offset:6144
  ds_read_b64_tr_b16 a[252:253], v91 offset:8192
  ds_read_b64_tr_b16 a[254:255], v91 offset:10240
  s_waitcnt vmcnt(11)
  ds_read_b64_tr_b16 a[232:233], v14 offset:6144
  s_waitcnt lgkmcnt(9)
  v_mfma_f32_32x32x16_bf16 v[48:63], a[120:123], v[140:143], v[48:63]
  ds_read_b64_tr_b16 a[112:113], v91 offset:12288
  ds_read_b64_tr_b16 a[114:115], v91 offset:14336
  ds_read_b64_tr_b16 a[234:235], v14 offset:7168
  ds_read_b64_tr_b16 a[236:237], v15 offset:6144
  ds_read_b64_tr_b16 a[238:239], v15 offset:7168
  v_mfma_f32_32x32x16_bf16 v[48:63], a[124:127], v[144:147], v[48:63]
  ds_read_b64_tr_b16 a[116:117], v91 offset:16384
  ds_read_b64_tr_b16 a[118:119], v91 offset:18432
  s_waitcnt lgkmcnt(12)
  v_mfma_f32_32x32x16_bf16 v[48:63], a[240:243], v[148:151], v[48:63]
  s_mul_i32 s61, s39, 14
  s_add_u32 m0, s74, 4096
  s_add_u32 s61, s61, s77
  buffer_load_dwordx4 v1, s[28:31], s61 offen  lds
  ds_read_b64_tr_b16 a[120:121], v91 offset:20480
  v_mfma_f32_32x32x16_bf16 v[48:63], a[244:247], v[152:155], v[48:63]
  buffer_load_dwordx4 v255, s[28:31], s61 offen offset:1024  lds
  ds_read_b64_tr_b16 a[122:123], v91 offset:22528
  ds_read_b64_tr_b16 a[124:125], v91 offset:24576
  ds_read_b64_tr_b16 a[126:127], v91 offset:26624
  s_waitcnt lgkmcnt(12)
  v_mfma_f32_32x32x16_bf16 v[48:63], a[248:251], v[156:159], v[48:63]
  ds_read_b64_tr_b16 a[240:241], v91 offset:28672
  ds_read_b64_tr_b16 a[242:243], v91 offset:30720
  s_waitcnt vmcnt(11)
  ds_read_b64_tr_b16 a[0:1], v14 offset:8192
  ds_read_b64_tr_b16 a[2:3], v14 offset:9216
  v_mfma_f32_32x32x16_bf16 v[48:63], a[252:255], v[160:163], v[48:63]
  ds_read_b64_tr_b16 a[244:245], v91 offset:32768
  ds_read_b64_tr_b16 a[246:247], v91 offset:34816
  ds_read_b64_tr_b16 a[4:5], v15 offset:8192
  ds_read_b64_tr_b16 a[6:7], v15 offset:9216
  s_waitcnt lgkmcnt(12)
  v_mfma_f32_32x32x16_bf16 v[48:63], a[112:115], v[164:167], v[48:63]
  s_mul_i32 s61, s40, 14
  s_add_u32 m0, s74, 6144
  s_add_u32 s61, s61, s77
  buffer_load_dwordx4 v1, s[28:31], s61 offen  lds
  ds_read_b64_tr_b16 a[248:249], v91 offset:36864
  v_mfma_f32_32x32x16_bf16 v[48:63], a[116:119], v[168:171], v[48:63]
  buffer_load_dwordx4 v255, s[28:31], s61 offen offset:1024  lds
  ds_read_b64_tr_b16 a[250:251], v91 offset:38912
  ds_read_b64_tr_b16 a[252:253], v91 offset:40960
  ds_read_b64_tr_b16 a[254:255], v91 offset:43008
  s_waitcnt lgkmcnt(12)
  v_mfma_f32_32x32x16_bf16 v[48:63], a[120:123], v[172:175], v[48:63]
  ds_read_b64_tr_b16 a[112:113], v91 offset:45056
  ds_read_b64_tr_b16 a[114:115], v91 offset:47104
  ds_read_b64_tr_b16 a[116:117], v91 offset:49152
  s_waitcnt vmcnt(10)
  ds_read_b64_tr_b16 a[8:9], v14 offset:0
  ds_read_b64_tr_b16 a[10:11], v14 offset:1024
  v_mfma_f32_32x32x16_bf16 v[48:63], a[124:127], v[176:179], v[48:63]
  s_waitcnt vmcnt(9)
  v_cmp_ne_u32 vcc, s76, v241
  ds_read_b64_tr_b16 a[118:119], v91 offset:51200
  ds_read_b64_tr_b16 a[12:13], v15 offset:0
  ds_read_b64_tr_b16 a[14:15], v15 offset:1024
  s_waitcnt lgkmcnt(14)
  v_mfma_f32_32x32x16_bf16 v[48:63], a[240:243], v[180:183], v[48:63]
  s_cmp_lg_u64 vcc, 0
  s_cbranch_scc0 L_chk_18r
  L_chk_18:
  s_mov_b32 s68, 0
L_chk_18l:
  buffer_load_dword v241, v249, s[48:51], s10 offen offset:0 sc1
  s_add_u32 s68, s68, 1
  s_cmp_ge_u32 s68, 1048576
  s_cbranch_scc1 L_end
  s_waitcnt vmcnt(0)
  v_cmp_ne_u32 vcc, s6, v241
  s_nop 1
  s_cmp_lg_u64 vcc, 0
  s_cbranch_scc1 L_chk_18l
  s_cmp_eq_u32 s7, 0
  s_cbranch_scc1 L_chk_18r
  buffer_inv sc1
  s_waitcnt vmcnt(0)
L_chk_18r:
  v_xor_b32 v250, 2048, v250
  v_xor_b32 v251, 2048, v251
  buffer_load_dwordx4 v[96:99], v250, s[48:51], s36 offen sc1
  v_mfma_f32_32x32x16_bf16 v[48:63], a[244:247], v[184:187], v[48:63]
  buffer_load_dwordx4 v[100:103], v251, s[48:51], s36 offen sc1
  ds_read_b64_tr_b16 a[120:121], v91 offset:53248
  ds_read_b64_tr_b16 a[122:123], v91 offset:55296
  v_accvgpr_write_b32 a124, v22
  v_accvgpr_write_b32 a125, v22
  s_waitcnt lgkmcnt(10)
  v_mfma_f32_32x32x16_bf16 v[48:63], a[248:251], v[188:191], v[48:63]
  buffer_load_dwordx4 v[104:107], v250, s[48:51], s37 offen sc1
  s_mul_i32 s61, s41, 14
  s_add_u32 m0, s74, 8192
  s_add_u32 s61, s61, s77
  buffer_load_dwordx4 v1, s[28:31], s61 offen  lds
  v_mfma_f32_32x32x16_bf16 v[48:63], a[252:255], v[192:195], v[48:63]
  buffer_load_dwordx4 v[108:111], v251, s[48:51], s37 offen sc1
  buffer_load_dwordx4 v255, s[28:31], s61 offen offset:1024  lds
  s_waitcnt lgkmcnt(4)
  v_mfma_f32_32x32x16_bf16 v[48:63], a[112:115], v[196:199], v[48:63]
  buffer_load_dword v241, v249, s[48:51], s10 offen offset:256 sc1
  buffer_load_dwordx4 v[112:115], v250, s[48:51], s38 offen sc1
  v_mfma_f32_32x32x16_bf16 v[48:63], a[116:119], v[200:203], v[48:63]
  buffer_load_dwordx4 v[116:119], v251, s[48:51], s38 offen sc1
  s_waitcnt vmcnt(14)
  ds_read_b64_tr_b16 a[16:17], v14 offset:2048
  s_waitcnt lgkmcnt(1)
  v_mfma_f32_32x32x16_bf16 v[48:63], a[120:123], v[204:207], v[48:63]
  buffer_load_dwordx4 v[120:123], v250, s[48:51], s39 offen sc1
  ds_read_b64_tr_b16 a[18:19], v14 offset:3072
  ds_read_b64_tr_b16 a[20:21], v15 offset:2048
  ds_read_b64_tr_b16 a[22:23], v15 offset:3072
  v_mfma_f32_32x32x16_bf16 v[48:63], a[124:127], v[92:95], v[48:63]
  buffer_load_dwordx4 v[124:127], v251, s[48:51], s39 offen sc1
  s_waitcnt vmcnt(10)
  v_mfma_f32_32x32x16_bf16 a[112:127], a[132:135], v[96:99], 0
  buffer_load_dwordx4 v[128:131], v250, s[48:51], s40 offen sc1
  s_mul_i32 s61, s42, 14
  s_add_u32 m0, s74, 0
  s_add_u32 s61, s61, s77
  buffer_load_dwordx4 v1, s[28:31], s61 offen  lds
  v_mfma_f32_32x32x16_bf16 v[208:223], a[128:131], v[96:99], 0
  s_cmp_lg_u32 s7, 0
  s_cbranch_scc1 L_rel_21
  buffer_store_dword v3, v254, s[48:51], s8 offen offset:512
L_rel_21r:
  ds_read_b64_tr_b16 a[24:25], v14 offset:4096
  ds_read_b64_tr_b16 a[26:27], v14 offset:5120
  s_waitcnt vmcnt(12)
  v_mfma_f32_32x32x16_bf16 a[240:255], a[132:135], v[100:103], 0
  buffer_load_dwordx4 v[132:135], v251, s[48:51], s40 offen sc1
  buffer_load_dwordx4 v255, s[28:31], s61 offen offset:1024  lds
  ds_read_b64_tr_b16 a[28:29], v15 offset:4096
  ds_read_b64_tr_b16 a[30:31], v15 offset:5120
  v_mfma_f32_32x32x16_bf16 v[224:239], a[128:131], v[100:103], 0
  s_xor_b32 s75, s75, 2048
  v_max_f32 v48, 0, v48
  v_max_f32 v49, 0, v49
  v_max_f32 v50, 0, v50
  v_max_f32 v51, 0, v51
  v_max_f32 v52, 0, v52
  v_max_f32 v53, 0, v53
  v_max_f32 v54, 0, v54
  v_max_f32 v55, 0, v55
  v_mul_f32 v48, v48, v48
  s_waitcnt vmcnt(13)
  v_mfma_f32_32x32x16_bf16 a[112:127], a[140:143], v[104:107], a[112:127]
  buffer_load_dwordx4 v[136:139], v250, s[48:51], s41 offen sc1
  v_mul_f32 v49, v49, v49
  v_mul_f32 v50, v50, v50
  v_mul_f32 v51, v51, v51
  v_mul_f32 v52, v52, v52
  v_mul_f32 v53, v53, v53
  v_mul_f32 v54, v54, v54
  v_mul_f32 v55, v55, v55
  v_mfma_f32_32x32x16_bf16 v[208:223], a[136:139], v[104:107], v[208:223]
  s_waitcnt lgkmcnt(4)
  s_mul_i32 s61, s36, 14
  s_add_u32 m0, s74, 2048
  s_add_u32 s77, s77, 28672
  s_add_u32 s61, s61, s77
  buffer_load_dwordx4 v1, s[28:31], s61 offen  lds
  v_cvt_pk_bf16_f32 v48, v48, v49
  s_waitcnt vmcnt(13)
  v_mfma_f32_32x32x16_bf16 a[240:255], a[140:143], v[108:111], a[240:255]
  buffer_load_dwordx4 v[140:143], v251, s[48:51], s41 offen sc1
  v_cvt_pk_bf16_f32 v49, v50, v51
  v_cvt_pk_bf16_f32 v50, v52, v53
  v_cvt_pk_bf16_f32 v51, v54, v55
  buffer_store_dwordx4 v[48:51], v2, s[48:51], s59 offen offset:0
  ds_read_b64_tr_b16 a[32:33], v14 offset:6144
  v_mfma_f32_32x32x16_bf16 v[224:239], a[136:139], v[108:111], v[224:239]
  buffer_load_dwordx4 v255, s[28:31], s61 offen offset:1024  lds
  v_max_f32 v56, 0, v56
  v_max_f32 v57, 0, v57
  v_max_f32 v58, 0, v58
  v_max_f32 v59, 0, v59
  v_max_f32 v60, 0, v60
  v_max_f32 v61, 0, v61
  ds_read_b64_tr_b16 a[34:35], v14 offset:7168
  ds_read_b64_tr_b16 a[36:37], v15 offset:6144
  s_waitcnt vmcnt(13)
  v_mfma_f32_32x32x16_bf16 a[112:127], a[148:151], v[112:115], a[112:127]
  buffer_load_dwordx4 v[144:147], v250, s[48:51], s42 offen sc1
  v_max_f32 v62, 0, v62
  v_max_f32 v63, 0, v63
  v_mul_f32 v56, v56, v56
  v_mul_f32 v57, v57, v57
  v_mul_f32 v58, v58, v58
  v_mul_f32 v59, v59, v59
  v_mul_f32 v60, v60, v60
  ds_read_b64_tr_b16 a[38:39], v15 offset:7168
  v_mfma_f32_32x32x16_bf16 v[208:223], a[144:147], v[112:115], v[208:223]
  v_mul_f32 v61, v61, v61
  v_mul_f32 v62, v62, v62
  v_mul_f32 v63, v63, v63
  v_cvt_pk_bf16_f32 v56, v56, v57
  v_cvt_pk_bf16_f32 v57, v58, v59
  v_cvt_pk_bf16_f32 v58, v60, v61
  v_cvt_pk_bf16_f32 v59, v62, v63
  buffer_store_dwordx4 v[56:59], v2, s[48:51], s59 offen offset:1024
  s_waitcnt vmcnt(14)
  v_mfma_f32_32x32x16_bf16 a[240:255], a[148:151], v[116:119], a[240:255]
  buffer_load_dwordx4 v[148:151], v251, s[48:51], s42 offen sc1
  v_mfma_f32_32x32x16_bf16 v[224:239], a[144:147], v[116:119], v[224:239]
  v_cmp_ne_u32 vcc, s76, v241
  s_waitcnt lgkmcnt(4)
  s_mul_i32 s61, s37, 14
  s_add_u32 m0, s74, 4096
  s_add_u32 s61, s61, s77
  buffer_load_dwordx4 v1, s[28:31], s61 offen  lds
  s_waitcnt vmcnt(15)
  v_mfma_f32_32x32x16_bf16 a[112:127], a[156:159], v[120:123], a[112:127]
  s_cmp_lg_u64 vcc, 0
  s_cbranch_scc1 L_chk_20
L_chk_20r:
  v_xor_b32 v250, 2048, v250
  v_xor_b32 v251, 2048, v251
  buffer_load_dwordx4 v[152:155], v250, s[48:51], s36 offen sc1
  v_mfma_f32_32x32x16_bf16 v[208:223], a[152:155], v[120:123], v[208:223]
  buffer_load_dwordx4 v255, s[28:31], s61 offen offset:1024  lds
  s_waitcnt vmcnt(16)
  v_mfma_f32_32x32x16_bf16 a[240:255], a[156:159], v[124:127], a[240:255]
  buffer_load_dwordx4 v[156:159], v251, s[48:51], s36 offen sc1
  ds_read_b64_tr_b16 a[40:41], v14 offset:8192
  v_mfma_f32_32x32x16_bf16 v[224:239], a[152:155], v[124:127], v[224:239]
  ds_read_b64_tr_b16 a[42:43], v14 offset:9216
  ds_read_b64_tr_b16 a[44:45], v15 offset:8192
  ds_read_b64_tr_b16 a[46:47], v15 offset:9216
  s_waitcnt vmcnt(16)
  v_mfma_f32_32x32x16_bf16 a[112:127], a[164:167], v[128:131], a[112:127]
  buffer_load_dwordx4 v[160:163], v250, s[48:51], s37 offen sc1
  v_mfma_f32_32x32x16_bf16 v[208:223], a[160:163], v[128:131], v[208:223]
  s_waitcnt lgkmcnt(4)
  s_mul_i32 s61, s38, 14
  s_add_u32 m0, s74, 6144
  s_add_u32 s61, s61, s77
  buffer_load_dwordx4 v1, s[28:31], s61 offen  lds
  s_waitcnt vmcnt(15)
  v_mfma_f32_32x32x16_bf16 a[240:255], a[164:167], v[132:135], a[240:255]
  buffer_load_dwordx4 v[164:167], v251, s[48:51], s37 offen sc1
  s_waitcnt vmcnt(15)
  ds_read_b64_tr_b16 a[48:49], v14 offset:0
  v_mfma_f32_32x32x16_bf16 v[224:239], a[160:163], v[132:135], v[224:239]
  buffer_load_dwordx4 v255, s[28:31], s61 offen offset:1024  lds
  ds_read_b64_tr_b16 a[50:51], v14 offset:1024
  s_waitcnt vmcnt(15)
  v_mfma_f32_32x32x16_bf16 a[112:127], a[172:175], v[136:139], a[112:127]
  buffer_load_dwordx4 v[168:171], v250, s[48:51], s38 offen sc1
  ds_read_b64_tr_b16 a[52:53], v15 offset:0
  ds_read_b64_tr_b16 a[54:55], v15 offset:1024
  v_mfma_f32_32x32x16_bf16 v[208:223], a[168:171], v[136:139], v[208:223]
  s_waitcnt lgkmcnt(4)
  s_mul_i32 s61, s39, 14
  s_add_u32 m0, s74, 8192
  s_add_u32 s61, s61, s77
  buffer_load_dwordx4 v1, s[28:31], s61 offen  lds
  s_waitcnt vmcnt(15)
  v_mfma_f32_32x32x16_bf16 a[240:255], a[172:175], v[140:143], a[240:255]
  buffer_load_dword v241, v249, s[48:51], s10 offen offset:512 sc1
  buffer_load_dwordx4 v[172:175], v251, s[48:51], s38 offen sc1
  v_mfma_f32_32x32x16_bf16 v[224:239], a[168:171], v[140:143], v[224:239]
  buffer_load_dwordx4 v255, s[28:31], s61 offen offset:1024  lds
  s_waitcnt vmcnt(16)
  ds_read_b64_tr_b16 a[56:57], v14 offset:2048
  s_waitcnt vmcnt(15)
  v_mfma_f32_32x32x16_bf16 a[112:127], a[180:183], v[144:147], a[112:127]
  s_cmp_lg_u32 s7, 0
  s_waitcnt vmcnt(14)
  s_cbranch_scc1 L_rel_23
  buffer_store_dword v3, v254, s[48:51], s8 offen offset:768
L_rel_23r:
  buffer_load_dwordx4 v[176:179], v250, s[48:51], s39 offen sc1
  v_mfma_f32_32x32x16_bf16 v[208:223], a[176:179], v[144:147], v[208:223]
  s_barrier
  ds_read_b32 v248, v9
  ds_read_b64_tr_b16 a[58:59], v14 offset:3072
  ds_read_b64_tr_b16 a[60:61], v15 offset:2048
  s_waitcnt vmcnt(15)
  v_mfma_f32_32x32x16_bf16 a[240:255], a[180:183], v[148:151], a[240:255]
  buffer_load_dwordx4 v[180:183], v251, s[48:51], s39 offen sc1
  ds_read_b64_tr_b16 a[62:63], v15 offset:3072
  s_xor_b32 s63, s3, 1
  v_mfma_f32_32x32x16_bf16 v[224:239], a[176:179], v[148:151], v[224:239]
  s_waitcnt lgkmcnt(5)
  s_mul_i32 s61, s40, 14
  s_add_u32 m0, s74, 0
  s_add_u32 s61, s61, s77
  buffer_load_dwordx4 v1, s[28:31], s61 offen  lds
  s_waitcnt vmcnt(15)
  v_mfma_f32_32x32x16_bf16 a[112:127], a[188:191], v[152:155], a[112:127]
  buffer_load_dwordx4 v[184:187], v250, s[48:51], s40 offen sc1
  s_waitcnt vmcnt(15)
  ds_read_b64_tr_b16 a[64:65], v14 offset:4096
  v_mfma_f32_32x32x16_bf16 v[208:223], a[184:187], v[152:155], v[208:223]
  buffer_load_dwordx4 v255, s[28:31], s61 offen offset:1024  lds
  s_mul_i32 s63, s63, 12288
  s_waitcnt vmcnt(15)
  v_mfma_f32_32x32x16_bf16 a[240:255], a[188:191], v[156:159], a[240:255]
  buffer_load_dwordx4 v[188:191], v251, s[48:51], s40 offen sc1
  ds_read_b64_tr_b16 a[66:67], v14 offset:5120
  v_add_u32 v245, s63, v2
  v_mfma_f32_32x32x16_bf16 v[224:239], a[184:187], v[156:159], v[224:239]
  ds_read_b64_tr_b16 a[68:69], v15 offset:4096
  ds_read_b64_tr_b16 a[70:71], v15 offset:5120
  s_xor_b32 s63, s3, 2
  s_mul_i32 s63, s63, 12288
  s_waitcnt vmcnt(15)
  v_mfma_f32_32x32x16_bf16 a[112:127], a[196:199], v[160:163], a[112:127]
  buffer_load_dwordx4 v[192:195], v250, s[48:51], s41 offen sc1
  v_add_u32 v246, s63, v2
  s_xor_b32 s63, s3, 3
  v_mfma_f32_32x32x16_bf16 v[208:223], a[192:195], v[160:163], v[208:223]
  s_waitcnt lgkmcnt(4)
  s_mul_i32 s61, s41, 14
  s_add_u32 m0, s74, 2048
  s_add_u32 s61, s61, s77
  buffer_load_dwordx4 v1, s[28:31], s61 offen  lds
  s_waitcnt vmcnt(15)
  v_mfma_f32_32x32x16_bf16 a[240:255], a[196:199], v[164:167], a[240:255]
  buffer_load_dwordx4 v[196:199], v251, s[48:51], s41 offen sc1
  s_waitcnt vmcnt(15)
  ds_read_b64_tr_b16 a[72:73], v14 offset:6144
  v_mfma_f32_32x32x16_bf16 v[224:239], a[192:195], v[164:167], v[224:239]
  buffer_load_dwordx4 v255, s[28:31], s61 offen offset:1024  lds
  s_mul_i32 s63, s63, 12288
  s_waitcnt vmcnt(15)
  v_mfma_f32_32x32x16_bf16 a[112:127], a[204:207], v[168:171], a[112:127]
  buffer_load_dwordx4 v[200:203], v250, s[48:51], s42 offen sc1
  ds_read_b64_tr_b16 a[74:75], v14 offset:7168
  v_add_u32 v247, s63, v2
  v_mfma_f32_32x32x16_bf16 v[208:223], a[200:203], v[168:171], v[208:223]
  s_waitcnt vmcnt(14)
  v_cmp_ne_u32 vcc, s76, v241
  ds_read_b64_tr_b16 a[76:77], v15 offset:6144
  ds_read_b64_tr_b16 a[78:79], v15 offset:7168
  s_mul_i32 s63, s3, 12288
  s_waitcnt vmcnt(13)
  v_mfma_f32_32x32x16_bf16 a[240:255], a[204:207], v[172:175], a[240:255]
  s_cmp_lg_u64 vcc, 0
  s_cbranch_scc1 L_chk_22
L_chk_22r:
  buffer_load_dwordx4 v[204:207], v251, s[48:51], s42 offen sc1
  v_mfma_f32_32x32x16_bf16 v[224:239], a[200:203], v[172:175], v[224:239]
  s_waitcnt lgkmcnt(4)
  s_mul_i32 s61, s42, 14
  s_add_u32 m0, s74, 4096
  s_add_u32 s61, s61, s77
  buffer_load_dwordx4 v1, s[28:31], s61 offen  lds
  s_waitcnt vmcnt(12)
  v_mfma_f32_32x32x16_bf16 a[112:127], a[212:215], v[176:179], a[112:127]
  buffer_load_dword v241, v249, s[48:51], s10 offen offset:768 sc1
  v_xor_b32 v250, 2048, v250
  v_xor_b32 v251, 2048, v251
  v_add_u32 v250, 4096, v250
  v_add_u32 v251, 4096, v251
  buffer_load_dwordx4 v[96:99], v251, s[48:51], s36 offen sc1
  v_mfma_f32_32x32x16_bf16 v[208:223], a[208:211], v[176:179], v[208:223]
  buffer_load_dwordx4 v255, s[28:31], s61 offen offset:1024  lds
  ds_read_b64_tr_b16 a[80:81], v14 offset:8192
  s_waitcnt vmcnt(14)
  v_mfma_f32_32x32x16_bf16 a[240:255], a[212:215], v[180:183], a[240:255]
  buffer_load_dwordx4 v[100:103], v251, s[48:51], s37 offen sc1
  ds_read_b64_tr_b16 a[82:83], v14 offset:9216
  ds_read_b64_tr_b16 a[84:85], v15 offset:8192
  ds_read_b64_tr_b16 a[86:87], v15 offset:9216
  v_mfma_f32_32x32x16_bf16 v[224:239], a[208:211], v[180:183], v[224:239]
  v_add_u32 v244, s63, v2
  s_mul_i32 s63, s3, 2560
  s_add_u32 s63, s63, 49152
  v_and_b32 v32, 31, v0
  s_waitcnt vmcnt(13)
  v_mfma_f32_32x32x16_bf16 a[112:127], a[220:223], v[184:187], a[112:127]
  buffer_load_dwordx4 v[104:107], v251, s[48:51], s38 offen sc1
  v_mul_u32_u24 v33, 896, v32
  v_sub_u32 v8, v8, v33
  v_mfma_f32_32x32x16_bf16 v[208:223], a[216:219], v[184:187], v[208:223]
  s_waitcnt vmcnt(13)
  ds_read_b64_tr_b16 a[88:89], v14 offset:0
  ds_read_b64_tr_b16 a[90:91], v14 offset:1024
  v_mul_u32_u24 v34, 80, v32
  v_lshrrev_b32 v32, 5, v0
  s_waitcnt vmcnt(12)
  v_mfma_f32_32x32x16_bf16 a[240:255], a[220:223], v[188:191], a[240:255]
  buffer_load_dwordx4 v[108:111], v251, s[48:51], s39 offen sc1
  v_lshlrev_b32 v33, 4, v32
  v_sub_u32 v8, v8, v33
  v_mfma_f32_32x32x16_bf16 v[224:239], a[216:219], v[188:191], v[224:239]
  ds_read_b64_tr_b16 a[92:93], v15 offset:0
  ds_read_b64_tr_b16 a[94:95], v15 offset:1024
  v_lshl_add_u32 v34, v32, 3, v34
  v_add_u32 v34, s63, v34
  s_waitcnt vmcnt(12)
  v_mfma_f32_32x32x16_bf16 a[112:127], a[228:231], v[192:195], a[112:127]
  buffer_load_dwordx4 v[112:115], v251, s[48:51], s40 offen sc1
  v_lshrrev_b32 v32, 2, v0
  v_mul_u32_u24 v33, 896, v32
  v_mfma_f32_32x32x16_bf16 v[208:223], a[224:227], v[192:195], v[208:223]
  v_add_u32 v8, v8, v33
  v_mul_u32_u24 v35, 80, v32
  v_and_b32 v32, 48, v2
  v_add_u32 v8, v8, v32
  s_waitcnt vmcnt(11)
  v_mfma_f32_32x32x16_bf16 a[240:255], a[228:231], v[196:199], a[240:255]
  buffer_load_dwordx4 v[116:119], v251, s[48:51], s41 offen sc1
  v_add3_u32 v35, v35, v32, s63
  s_mov_b32 s63, 14336
  v_mfma_f32_32x32x16_bf16 v[224:239], a[224:227], v[196:199], v[224:239]
  s_waitcnt vmcnt(11)
  ds_read_b64_tr_b16 a[96:97], v14 offset:2048
  ds_read_b64_tr_b16 a[98:99], v14 offset:3072
  v_lshlrev_b32 v32, 16, v24
  v_and_b32 v33, 0xffff0000, v24
  s_waitcnt vmcnt(10)
  v_mfma_f32_32x32x16_bf16 a[112:127], a[236:239], v[200:203], a[112:127]
  buffer_load_dwordx4 v[120:123], v251, s[48:51], s42 offen sc1
  v_lshlrev_b32 v48, 16, v80
  v_and_b32 v49, 0xffff0000, v80
  v_mfma_f32_32x32x16_bf16 v[208:223], a[232:235], v[200:203], v[208:223]
  ds_read_b64_tr_b16 a[100:101], v15 offset:2048
  ds_read_b64_tr_b16 a[102:103], v15 offset:3072
  v_fmac_f32 v64, v32, v48
  v_fmac_f32 v65, v33, v49
  s_waitcnt vmcnt(10)
  v_mfma_f32_32x32x16_bf16 a[240:255], a[236:239], v[204:207], a[240:255]
  v_mul_f32 v48, v248, v48
  v_mul_f32 v49, v248, v49
  v_lshlrev_b32 v32, 16, v25
  v_and_b32 v33, 0xffff0000, v25
  v_lshlrev_b32 v50, 16, v81
  v_mfma_f32_32x32x16_bf16 v[224:239], a[232:235], v[204:207], v[224:239]
  s_waitcnt vmcnt(8)
  v_cmp_ne_u32 vcc, s76, v241
  v_and_b32 v51, 0xffff0000, v81
  v_fmac_f32 v66, v32, v50
  v_fmac_f32 v67, v33, v51
  s_waitcnt vmcnt(7)
  v_mfma_f32_32x32x16_bf16 a[240:255], a[4:7], v[96:99], a[240:255]
  s_cmp_lg_u64 vcc, 0
  s_cbranch_scc0 L_chk_24r
  L_chk_24:
  s_mov_b32 s68, 0
L_chk_24l:
  buffer_load_dword v241, v249, s[48:51], s10 offen offset:768 sc1
  s_add_u32 s68, s68, 1
  s_cmp_ge_u32 s68, 1048576
  s_cbranch_scc1 L_end
  s_waitcnt vmcnt(0)
  v_cmp_ne_u32 vcc, s6, v241
  s_nop 1
  s_cmp_lg_u64 vcc, 0
  s_cbranch_scc1 L_chk_24l
  s_cmp_eq_u32 s7, 0
  s_cbranch_scc1 L_chk_24r
  buffer_inv sc1
  s_waitcnt vmcnt(0)
L_chk_24r:
  s_lshr_b32 s62, s36, 2
  buffer_load_dwordx4 v[124:127], v253, s[48:51], s62 offen sc1
  v_mfma_f32_32x32x16_bf16 v[224:239], a[0:3], v[96:99], v[224:239]
  s_lshr_b32 s62, s37, 2
  buffer_load_dwordx4 v[128:131], v253, s[48:51], s62 offen sc1
  s_waitcnt vmcnt(7)
  v_mfma_f32_32x32x16_bf16 a[240:255], a[12:15], v[100:103], a[240:255]
  s_lshr_b32 s62, s38, 2
  buffer_load_dwordx4 v[132:135], v253, s[48:51], s62 offen sc1
  v_mul_f32 v50, v248, v50
  v_mfma_f32_32x32x16_bf16 v[224:239], a[8:11], v[100:103], v[224:239]
  ds_read_b64_tr_b16 a[104:105], v14 offset:4096
  ds_read_b64_tr_b16 a[106:107], v14 offset:5120
  ds_read_b64_tr_b16 a[108:109], v15 offset:4096
  ds_read_b64_tr_b16 a[110:111], v15 offset:5120
  s_waitcnt vmcnt(7)
  v_mfma_f32_32x32x16_bf16 a[240:255], a[20:23], v[104:107], a[240:255]
  s_lshr_b32 s62, s39, 2
  buffer_load_dwordx4 v[136:139], v253, s[48:51], s62 offen sc1
  v_mul_f32 v51, v248, v51
  v_mfma_f32_32x32x16_bf16 v[224:239], a[16:19], v[104:107], v[224:239]
  v_lshlrev_b32 v32, 16, v26
  v_and_b32 v33, 0xffff0000, v26
  v_lshlrev_b32 v52, 16, v82
  v_and_b32 v53, 0xffff0000, v82
  s_waitcnt vmcnt(7)
  v_mfma_f32_32x32x16_bf16 a[240:255], a[28:31], v[108:111], a[240:255]
  s_lshr_b32 s62, s40, 2
  buffer_load_dwordx4 v[140:143], v253, s[48:51], s62 offen sc1
  v_fmac_f32 v68, v32, v52
  v_mfma_f32_32x32x16_bf16 v[224:239], a[24:27], v[108:111], v[224:239]
  v_fmac_f32 v69, v33, v53
  v_mul_f32 v52, v248, v52
  v_mul_f32 v53, v248, v53
  v_lshlrev_b32 v32, 16, v27
  s_waitcnt vmcnt(7)
  v_mfma_f32_32x32x16_bf16 a[240:255], a[36:39], v[112:115], a[240:255]
  s_lshr_b32 s62, s41, 2
  buffer_load_dwordx4 v[144:147], v253, s[48:51], s62 offen sc1
  v_and_b32 v33, 0xffff0000, v27
  v_mfma_f32_32x32x16_bf16 v[224:239], a[32:35], v[112:115], v[224:239]
  v_lshlrev_b32 v54, 16, v83
  v_and_b32 v55, 0xffff0000, v83
  v_fmac_f32 v70, v32, v54
  v_fmac_f32 v71, v33, v55
  s_waitcnt vmcnt(7)
  v_mfma_f32_32x32x16_bf16 a[240:255], a[44:47], v[116:119], a[240:255]
  s_lshr_b32 s62, s42, 2
  buffer_load_dwordx4 v[148:151], v253, s[48:51], s62 offen sc1
  v_mul_f32 v54, v248, v54
  v_mfma_f32_32x32x16_bf16 v[224:239], a[40:43], v[116:119], v[224:239]
  v_mul_f32 v55, v248, v55
  v_lshlrev_b32 v32, 16, v28
  v_and_b32 v33, 0xffff0000, v28
  v_lshlrev_b32 v56, 16, v84
  s_waitcnt vmcnt(7)
  v_mfma_f32_32x32x16_bf16 a[240:255], a[52:55], v[120:123], a[240:255]
  buffer_load_dwordx4 v[152:155], v250, s[48:51], s36 offen sc1
  v_and_b32 v57, 0xffff0000, v84
  v_fmac_f32 v72, v32, v56
  v_mfma_f32_32x32x16_bf16 v[224:239], a[48:51], v[120:123], v[224:239]
  v_fmac_f32 v73, v33, v57
  v_mul_f32 v56, v248, v56
  v_mul_f32 v57, v248, v57
  v_lshlrev_b32 v32, 16, v29
  s_waitcnt vmcnt(7)
  v_mfma_f32_32x32x16_bf16 a[240:255], a[60:63], v[124:127], a[240:255]
  buffer_load_dwordx4 v[156:159], v250, s[48:51], s37 offen sc1
  v_and_b32 v33, 0xffff0000, v29
  v_lshlrev_b32 v58, 16, v85
  v_mfma_f32_32x32x16_bf16 v[224:239], a[56:59], v[124:127], v[224:239]
  v_and_b32 v59, 0xffff0000, v85
  v_fmac_f32 v74, v32, v58
  v_fmac_f32 v75, v33, v59
  v_mul_f32 v58, v248, v58
  s_waitcnt vmcnt(7)
  v_mfma_f32_32x32x16_bf16 a[240:255], a[68:71], v[128:131], a[240:255]
  buffer_load_dwordx4 v[160:163], v250, s[48:51], s38 offen sc1
  v_mul_f32 v59, v248, v59
  v_lshlrev_b32 v32, 16, v30
  v_mfma_f32_32x32x16_bf16 v[224:239], a[64:67], v[128:131], v[224:239]
  v_and_b32 v33, 0xffff0000, v30
  v_lshlrev_b32 v60, 16, v86
  v_and_b32 v61, 0xffff0000, v86
  v_fmac_f32 v76, v32, v60
  s_waitcnt vmcnt(7) lgkmcnt(15)
  v_mfma_f32_32x32x16_bf16 a[240:255], a[76:79], v[132:135], a[240:255]
  buffer_load_dwordx4 v[164:167], v250, s[48:51], s39 offen sc1
  v_fmac_f32 v77, v33, v61
  v_mul_f32 v60, v248, v60
  v_mfma_f32_32x32x16_bf16 v[224:239], a[72:75], v[132:135], v[224:239]
  v_mul_f32 v61, v248, v61
  v_lshlrev_b32 v32, 16, v31
  v_and_b32 v33, 0xffff0000, v31
  v_lshlrev_b32 v62, 16, v87
  s_waitcnt vmcnt(7) lgkmcnt(12)
  v_mfma_f32_32x32x16_bf16 a[240:255], a[84:87], v[136:139], a[240:255]
  buffer_load_dwordx4 v[168:171], v250, s[48:51], s40 offen sc1
  v_and_b32 v63, 0xffff0000, v87
  v_fmac_f32 v78, v32, v62
  v_mfma_f32_32x32x16_bf16 v[224:239], a[80:83], v[136:139], v[224:239]
  v_fmac_f32 v79, v33, v63
  v_mul_f32 v62, v248, v62
  v_mul_f32 v63, v248, v63
  s_waitcnt vmcnt(7) lgkmcnt(8)
  v_mfma_f32_32x32x16_bf16 a[240:255], a[92:95], v[140:143], a[240:255]
  buffer_load_dwordx4 v[172:175], v250, s[48:51], s41 offen sc1
  v_mfma_f32_32x32x16_bf16 v[224:239], a[88:91], v[140:143], v[224:239]
  s_waitcnt vmcnt(7) lgkmcnt(4)
  v_mfma_f32_32x32x16_bf16 a[240:255], a[100:103], v[144:147], a[240:255]
  buffer_load_dwordx4 v[176:179], v250, s[48:51], s42 offen sc1
  v_mfma_f32_32x32x16_bf16 v[224:239], a[96:99], v[144:147], v[224:239]
  s_waitcnt vmcnt(7) lgkmcnt(0)
  v_mfma_f32_32x32x16_bf16 a[240:255], a[108:111], v[148:151], a[240:255]
  s_lshr_b32 s62, s36, 2
  buffer_load_dwordx4 v[180:183], v252, s[48:51], s62 offen sc1
  v_mfma_f32_32x32x16_bf16 v[224:239], a[104:107], v[148:151], v[224:239]
  s_waitcnt vmcnt(7)
  v_mfma_f32_32x32x16_bf16 a[112:127], a[4:7], v[152:155], a[112:127]
  s_lshr_b32 s62, s37, 2
  buffer_load_dwordx4 v[184:187], v252, s[48:51], s62 offen sc1
  v_mfma_f32_32x32x16_bf16 v[208:223], a[0:3], v[152:155], v[208:223]
  s_waitcnt vmcnt(7)
  v_mfma_f32_32x32x16_bf16 a[112:127], a[12:15], v[156:159], a[112:127]
  s_lshr_b32 s62, s38, 2
  buffer_load_dwordx4 v[188:191], v252, s[48:51], s62 offen sc1
  v_mfma_f32_32x32x16_bf16 v[208:223], a[8:11], v[156:159], v[208:223]
  ds_write_b128 v247, a[240:243] offset:8192
  s_waitcnt vmcnt(7)
  v_mfma_f32_32x32x16_bf16 a[112:127], a[20:23], v[160:163], a[112:127]
  s_lshr_b32 s62, s39, 2
  buffer_load_dwordx4 v[192:195], v252, s[48:51], s62 offen sc1
  ds_write_b128 v247, a[244:247] offset:9216
  v_mfma_f32_32x32x16_bf16 v[208:223], a[16:19], v[160:163], v[208:223]
  ds_write_b128 v247, a[248:251] offset:10240
  s_waitcnt vmcnt(7)
  v_mfma_f32_32x32x16_bf16 a[112:127], a[28:31], v[164:167], a[112:127]
  s_lshr_b32 s62, s40, 2
  buffer_load_dwordx4 v[196:199], v252, s[48:51], s62 offen sc1
  ds_write_b128 v247, a[252:255] offset:11264
  v_mfma_f32_32x32x16_bf16 v[208:223], a[24:27], v[164:167], v[208:223]
  ds_write_b128 v245, v[224:227] offset:0
  s_waitcnt vmcnt(7)
  v_mfma_f32_32x32x16_bf16 a[112:127], a[36:39], v[168:171], a[112:127]
  s_lshr_b32 s62, s41, 2
  buffer_load_dwordx4 v[200:203], v252, s[48:51], s62 offen sc1
  ds_write_b128 v245, v[228:231] offset:1024
  v_mfma_f32_32x32x16_bf16 v[208:223], a[32:35], v[168:171], v[208:223]
  ds_write_b128 v245, v[232:235] offset:2048
  s_waitcnt vmcnt(7)
  v_mfma_f32_32x32x16_bf16 a[112:127], a[44:47], v[172:175], a[112:127]
  s_lshr_b32 s62, s42, 2
  buffer_load_dwordx4 v[204:207], v252, s[48:51], s62 offen sc1
  ds_write_b128 v245, v[236:239] offset:3072
  v_mfma_f32_32x32x16_bf16 v[208:223], a[40:43], v[172:175], v[208:223]
  s_waitcnt vmcnt(7)
  v_mfma_f32_32x32x16_bf16 a[112:127], a[52:55], v[176:179], a[112:127]
  v_mfma_f32_32x32x16_bf16 v[208:223], a[48:51], v[176:179], v[208:223]
  s_waitcnt lgkmcnt(0)
  s_barrier
  ds_read_b128 v[96:99], v244 offset:0
  ds_read_b128 v[100:103], v244 offset:1024
  ds_read_b128 v[104:107], v244 offset:2048
  s_waitcnt vmcnt(6)
  v_mfma_f32_32x32x16_bf16 a[112:127], a[60:63], v[180:183], a[112:127]
  ds_read_b128 v[108:111], v244 offset:3072
  ds_read_b128 v[112:115], v244 offset:8192
  ds_read_b128 v[116:119], v244 offset:9216
  ds_read_b128 v[120:123], v244 offset:10240
  ds_read_b128 v[124:127], v244 offset:11264
  v_mfma_f32_32x32x16_bf16 v[208:223], a[56:59], v[180:183], v[208:223]
  s_waitcnt vmcnt(5)
  v_mfma_f32_32x32x16_bf16 a[112:127], a[68:71], v[184:187], a[112:127]
  v_mfma_f32_32x32x16_bf16 v[208:223], a[64:67], v[184:187], v[208:223]
  s_waitcnt vmcnt(4)
  v_mfma_f32_32x32x16_bf16 a[112:127], a[76:79], v[188:191], a[112:127]
  s_waitcnt lgkmcnt(7)
  v_fmac_f32 v64, v96, v48
  v_fmac_f32 v65, v97, v49
  v_fmac_f32 v66, v98, v50
  v_fmac_f32 v67, v99, v51
  s_waitcnt lgkmcnt(6)
  v_fmac_f32 v68, v100, v52
  v_fmac_f32 v69, v101, v53
  v_mfma_f32_32x32x16_bf16 v[208:223], a[72:75], v[188:191], v[208:223]
  v_fmac_f32 v70, v102, v54
  v_fmac_f32 v71, v103, v55
  s_waitcnt lgkmcnt(5)
  v_fmac_f32 v72, v104, v56
  v_fmac_f32 v73, v105, v57
  s_waitcnt vmcnt(3)
  v_mfma_f32_32x32x16_bf16 a[112:127], a[84:87], v[192:195], a[112:127]
  v_fmac_f32 v74, v106, v58
  v_fmac_f32 v75, v107, v59
  s_waitcnt lgkmcnt(4)
  v_fmac_f32 v76, v108, v60
  v_fmac_f32 v77, v109, v61
  v_fmac_f32 v78, v110, v62
  s_waitcnt vmcnt(2)
  v_mfma_f32_32x32x16_bf16 a[112:127], a[92:95], v[196:199], a[112:127]
  v_fmac_f32 v79, v111, v63
  s_waitcnt lgkmcnt(3)
  v_fmac_f32 v64, v112, v48
  v_fmac_f32 v65, v113, v49
  v_fmac_f32 v66, v114, v50
  v_fmac_f32 v67, v115, v51
  s_waitcnt vmcnt(1)
  v_mfma_f32_32x32x16_bf16 a[112:127], a[100:103], v[200:203], a[112:127]
  s_waitcnt lgkmcnt(2)
  v_fmac_f32 v68, v116, v52
  v_fmac_f32 v69, v117, v53
  s_waitcnt vmcnt(0)
  v_mfma_f32_32x32x16_bf16 a[112:127], a[108:111], v[204:207], a[112:127]
  v_fmac_f32 v70, v118, v54
  v_fmac_f32 v71, v119, v55
  s_waitcnt lgkmcnt(1)
  v_fmac_f32 v72, v120, v56
  v_fmac_f32 v73, v121, v57
  v_fmac_f32 v74, v122, v58
  v_mfma_f32_32x32x16_bf16 v[208:223], a[80:83], v[192:195], v[208:223]
  v_fmac_f32 v75, v123, v59
  s_waitcnt lgkmcnt(0)
  v_fmac_f32 v76, v124, v60
  v_fmac_f32 v77, v125, v61
  v_fmac_f32 v78, v126, v62
  v_fmac_f32 v79, v127, v63
  v_mfma_f32_32x32x16_bf16 v[208:223], a[88:91], v[196:199], v[208:223]
  ds_write_b128 v246, a[112:115] offset:4096
  ds_write_b128 v246, a[116:119] offset:5120
  ds_write_b128 v246, a[120:123] offset:6144
  ds_write_b128 v246, a[124:127] offset:7168
  v_mfma_f32_32x32x16_bf16 v[208:223], a[96:99], v[200:203], v[208:223]
  v_mfma_f32_32x32x16_bf16 v[208:223], a[104:107], v[204:207], v[208:223]
  s_waitcnt lgkmcnt(0)
  s_barrier
  ds_read_b128 v[128:131], v244 offset:4096
  ds_read_b128 v[132:135], v244 offset:5120
  ds_read_b128 v[136:139], v244 offset:6144
  ds_read_b128 v[140:143], v244 offset:7168
  s_nop 5
  v_pk_fma_f32 v[64:65], v[208:209], v[48:49], v[64:65]
  v_pk_fma_f32 v[66:67], v[210:211], v[50:51], v[66:67]
  v_pk_fma_f32 v[68:69], v[212:213], v[52:53], v[68:69]
  v_pk_fma_f32 v[70:71], v[214:215], v[54:55], v[70:71]
  v_pk_fma_f32 v[72:73], v[216:217], v[56:57], v[72:73]
  v_pk_fma_f32 v[74:75], v[218:219], v[58:59], v[74:75]
  v_pk_fma_f32 v[76:77], v[220:221], v[60:61], v[76:77]
  v_pk_fma_f32 v[78:79], v[222:223], v[62:63], v[78:79]
  s_waitcnt lgkmcnt(3)
  v_pk_fma_f32 v[64:65], v[128:129], v[48:49], v[64:65]
  v_pk_fma_f32 v[66:67], v[130:131], v[50:51], v[66:67]
  v_cvt_pk_bf16_f32 v160, v64, v65
  v_cvt_pk_bf16_f32 v161, v66, v67
  ds_write_b64 v34, v[160:161] offset:0
  s_waitcnt lgkmcnt(3)
  v_pk_fma_f32 v[68:69], v[132:133], v[52:53], v[68:69]
  v_pk_fma_f32 v[70:71], v[134:135], v[54:55], v[70:71]
  v_cvt_pk_bf16_f32 v162, v68, v69
  v_cvt_pk_bf16_f32 v163, v70, v71
  ds_write_b64 v34, v[162:163] offset:16
  s_waitcnt lgkmcnt(3)
  v_pk_fma_f32 v[72:73], v[136:137], v[56:57], v[72:73]
  v_pk_fma_f32 v[74:75], v[138:139], v[58:59], v[74:75]
  v_cvt_pk_bf16_f32 v164, v72, v73
  v_cvt_pk_bf16_f32 v165, v74, v75
  ds_write_b64 v34, v[164:165] offset:32
  s_waitcnt lgkmcnt(3)
  v_pk_fma_f32 v[76:77], v[140:141], v[60:61], v[76:77]
  v_pk_fma_f32 v[78:79], v[142:143], v[62:63], v[78:79]
  v_cvt_pk_bf16_f32 v166, v76, v77
  v_cvt_pk_bf16_f32 v167, v78, v79
  ds_write_b64 v34, v[166:167] offset:48
  ds_read_b128 v[168:171], v35 offset:0
  ds_read_b128 v[172:175], v35 offset:1280
  s_waitcnt lgkmcnt(1)
  buffer_store_dwordx4 v[168:171], v8, s[44:47], 0 offen
  s_waitcnt lgkmcnt(0)
  buffer_store_dwordx4 v[172:175], v8, s[44:47], s63 offen
  s_branch L_end
L_helper:
  s_waitcnt vmcnt(0) lgkmcnt(0)
  s_cmp_lg_u32 s7, 0
  s_mov_b64 exec, 1
  s_cbranch_scc1 L_rel_26
  buffer_store_dword v3, off, s[48:51], s74 offset:0
L_rel_26r:
  s_mov_b64 exec, -1
  s_getpc_b64 s[52:53]
L_pc2:
  s_sub_u32 s52, s52, L_pc2-L_p3
  s_subb_u32 s53, s53, 0
  s_mov_b32 s54, L_pc2-L_p3
  v_lshlrev_b32 v249, 7, v0
  s_and_b32 s61, s5, 1
  s_lshl2_add_u32 s61, s61, s3
  s_lshl_b32 s61, s61, 11
  s_mov_b64 exec, 0xffff
  buffer_load_dword v248, v249, s[52:55], s61 offen
  s_mov_b64 exec, -1
  s_cmp_eq_u32 s22, 0
  s_cbranch_scc1 L_nouv
  s_add_u32 m0, s13, 98304
  s_add_u32 s12, s69, 1376256
  buffer_load_dwordx4 v80, s[20:23], s12 offen offset:0  lds
  buffer_load_dwordx4 v81, s[20:23], s12 offen offset:1024  lds
  buffer_load_dwordx4 v82, s[20:23], s12 offen offset:2048  lds
  buffer_load_dwordx4 v83, s[20:23], s12 offen offset:3072  lds
  s_mov_b32 s68, 0
L_poll_27:
  buffer_load_dwordx4 v[56:59], v253, s[48:51], s56 offen offset:0 sc1
  buffer_load_dwordx4 v[60:63], v253, s[48:51], s56 offen offset:896 sc1
  s_add_u32 s68, s68, 1
  s_cmp_ge_u32 s68, 1048576
  s_cbranch_scc1 L_end
  s_waitcnt vmcnt(0)
  v_xor_b32 v64, s6, v58
  v_xor_b32 v65, s6, v62
  v_or_b32 v64, v64, v65
  v_cmp_ne_u32 vcc, 0, v64
  s_nop 0
  s_cmp_lg_u64 vcc, 0
  s_cbranch_scc1 L_poll_27
  ds_write_b64 v254, v[56:57]
  ds_write_b64 v254, v[60:61] offset:448
  s_lshl_b32 s64, s3, 6
  v_xor_b32 v96, s64, v10
  v_add_u32 v97, 57344, v96
  v_bfe_u32 v98, v0, 2, 1
  v_mul_u32_u24 v98, 896, v98
  v_sub_u32 v98, v247, v98
  v_add_u32 v98, 162048, v98
  v_lshlrev_b32 v9, 16, v9
  v_cndmask_b32 v9, 0, v9, s[62:63]
  v_lshlrev_b32 v245, 3, v0
  s_lshl2_add_u32 s64, s4, s3
  s_lshl_b32 s64, s64, 9
  s_add_u32 s64, s64, 262144
  s_waitcnt lgkmcnt(0)
  s_barrier
  ds_read_b128 v[208:211], v98 offset:0
  ds_read_b64_tr_b16 v[212:213], v96 offset:0
  ds_read_b64_tr_b16 v[214:215], v96 offset:2048
  ds_read_b128 v[216:219], v98 offset:32
  ds_read_b64_tr_b16 v[220:221], v96 offset:4096
  ds_read_b64_tr_b16 v[222:223], v96 offset:6144
  ds_read_b128 v[224:227], v98 offset:64
  ds_read_b64_tr_b16 v[228:229], v96 offset:8192
  ds_read_b64_tr_b16 v[230:231], v96 offset:10240
  s_waitcnt lgkmcnt(6)
  v_mfma_f32_32x32x16_bf16 v[192:207], v[208:211], v[212:215], 0
  ds_read_b128 v[232:235], v98 offset:96
  ds_read_b64_tr_b16 v[236:237], v96 offset:12288
  ds_read_b64_tr_b16 v[238:239], v96 offset:14336
  s_waitcnt lgkmcnt(6)
  v_mfma_f32_32x32x16_bf16 v[192:207], v[216:219], v[220:223], v[192:207]
  ds_read_b128 v[208:211], v98 offset:128
  ds_read_b64_tr_b16 v[212:213], v96 offset:16384
  ds_read_b64_tr_b16 v[214:215], v96 offset:18432
  s_waitcnt lgkmcnt(6)
  v_mfma_f32_32x32x16_bf16 v[192:207], v[224:227], v[228:231], v[192:207]
  ds_read_b128 v[216:219], v98 offset:160
  ds_read_b64_tr_b16 v[220:221], v96 offset:20480
  ds_read_b64_tr_b16 v[222:223], v96 offset:22528
  s_waitcnt lgkmcnt(6)
  v_mfma_f32_32x32x16_bf16 v[192:207], v[232:235], v[236:239], v[192:207]
  ds_read_b128 v[224:227], v98 offset:192
  ds_read_b64_tr_b16 v[228:229], v96 offset:24576
  ds_read_b64_tr_b16 v[230:231], v96 offset:26624
  s_waitcnt lgkmcnt(6)
  v_mfma_f32_32x32x16_bf16 v[192:207], v[208:211], v[212:215], v[192:207]
  ds_read_b128 v[232:235], v98 offset:224
  ds_read_b64_tr_b16 v[236:237], v96 offset:28672
  ds_read_b64_tr_b16 v[238:239], v96 offset:30720
  s_waitcnt lgkmcnt(6)
  v_mfma_f32_32x32x16_bf16 v[192:207], v[216:219], v[220:223], v[192:207]
  ds_read_b128 v[208:211], v98 offset:256
  ds_read_b64_tr_b16 v[212:213], v96 offset:32768
  ds_read_b64_tr_b16 v[214:215], v96 offset:34816
  s_waitcnt lgkmcnt(6)
  v_mfma_f32_32x32x16_bf16 v[192:207], v[224:227], v[228:231], v[192:207]
  ds_read_b128 v[216:219], v98 offset:288
  ds_read_b64_tr_b16 v[220:221], v96 offset:36864
  ds_read_b64_tr_b16 v[222:223], v96 offset:38912
  s_waitcnt lgkmcnt(6)
  v_mfma_f32_32x32x16_bf16 v[192:207], v[232:235], v[236:239], v[192:207]
  ds_read_b128 v[224:227], v98 offset:320
  ds_read_b64_tr_b16 v[228:229], v96 offset:40960
  ds_read_b64_tr_b16 v[230:231], v96 offset:43008
  s_waitcnt lgkmcnt(6)
  v_mfma_f32_32x32x16_bf16 v[192:207], v[208:211], v[212:215], v[192:207]
  ds_read_b128 v[232:235], v98 offset:352
  ds_read_b64_tr_b16 v[236:237], v96 offset:45056
  ds_read_b64_tr_b16 v[238:239], v96 offset:47104
  s_waitcnt lgkmcnt(6)
  v_mfma_f32_32x32x16_bf16 v[192:207], v[216:219], v[220:223], v[192:207]
  ds_read_b128 v[208:211], v98 offset:384
  ds_read_b64_tr_b16 v[212:213], v96 offset:49152
  ds_read_b64_tr_b16 v[214:215], v96 offset:51200
  s_waitcnt lgkmcnt(6)
  v_mfma_f32_32x32x16_bf16 v[192:207], v[224:227], v[228:231], v[192:207]
  ds_read_b128 v[216:219], v98 offset:416
  ds_read_b64_tr_b16 v[220:221], v96 offset:53248
  ds_read_b64_tr_b16 v[222:223], v96 offset:55296
  s_waitcnt lgkmcnt(6)
  v_mfma_f32_32x32x16_bf16 v[192:207], v[232:235], v[236:239], v[192:207]
  ds_read_b128 v[224:227], v98 offset:448
  ds_read_b64_tr_b16 v[228:229], v97 offset:0
  ds_read_b64_tr_b16 v[230:231], v97 offset:2048
  s_waitcnt lgkmcnt(6)
  v_mfma_f32_32x32x16_bf16 v[192:207], v[208:211], v[212:215], v[192:207]
  ds_read_b128 v[232:235], v98 offset:480
  ds_read_b64_tr_b16 v[236:237], v97 offset:4096
  ds_read_b64_tr_b16 v[238:239], v97 offset:6144
  s_waitcnt lgkmcnt(6)
  v_mfma_f32_32x32x16_bf16 v[192:207], v[216:219], v[220:223], v[192:207]
  ds_read_b128 v[208:211], v98 offset:512
  ds_read_b64_tr_b16 v[212:213], v97 offset:8192
  ds_read_b64_tr_b16 v[214:215], v97 offset:10240
  s_waitcnt lgkmcnt(6)
  v_mfma_f32_32x32x16_bf16 v[192:207], v[224:227], v[228:231], v[192:207]
  ds_read_b128 v[216:219], v98 offset:544
  ds_read_b64_tr_b16 v[220:221], v97 offset:12288
  ds_read_b64_tr_b16 v[222:223], v97 offset:14336
  s_waitcnt lgkmcnt(6)
  v_mfma_f32_32x32x16_bf16 v[192:207], v[232:235], v[236:239], v[192:207]
  ds_read_b128 v[224:227], v98 offset:576
  ds_read_b64_tr_b16 v[228:229], v97 offset:16384
  ds_read_b64_tr_b16 v[230:231], v97 offset:18432
  s_waitcnt lgkmcnt(6)
  v_mfma_f32_32x32x16_bf16 v[192:207], v[208:211], v[212:215], v[192:207]
  ds_read_b128 v[232:235], v98 offset:608
  ds_read_b64_tr_b16 v[236:237], v97 offset:20480
  ds_read_b64_tr_b16 v[238:239], v97 offset:22528
  s_waitcnt lgkmcnt(6)
  v_mfma_f32_32x32x16_bf16 v[192:207], v[216:219], v[220:223], v[192:207]
  ds_read_b128 v[208:211], v98 offset:640
  ds_read_b64_tr_b16 v[212:213], v97 offset:24576
  ds_read_b64_tr_b16 v[214:215], v97 offset:26624
  s_waitcnt lgkmcnt(6)
  v_mfma_f32_32x32x16_bf16 v[192:207], v[224:227], v[228:231], v[192:207]
  ds_read_b128 v[216:219], v98 offset:672
  ds_read_b64_tr_b16 v[220:221], v97 offset:28672
  ds_read_b64_tr_b16 v[222:223], v97 offset:30720
  s_waitcnt lgkmcnt(6)
  v_mfma_f32_32x32x16_bf16 v[192:207], v[232:235], v[236:239], v[192:207]
  ds_read_b128 v[224:227], v98 offset:704
  ds_read_b64_tr_b16 v[228:229], v97 offset:32768
  ds_read_b64_tr_b16 v[230:231], v97 offset:34816
  s_waitcnt lgkmcnt(6)
  v_mfma_f32_32x32x16_bf16 v[192:207], v[208:211], v[212:215], v[192:207]
  ds_read_b128 v[232:235], v98 offset:736
  ds_read_b64_tr_b16 v[236:237], v97 offset:36864
  ds_read_b64_tr_b16 v[238:239], v97 offset:38912
  s_waitcnt lgkmcnt(6)
  v_mfma_f32_32x32x16_bf16 v[192:207], v[216:219], v[220:223], v[192:207]
  ds_read_b128 v[208:211], v98 offset:768
  ds_read_b64_tr_b16 v[212:213], v97 offset:40960
  ds_read_b64_tr_b16 v[214:215], v97 offset:43008
  s_waitcnt lgkmcnt(6)
  v_mfma_f32_32x32x16_bf16 v[192:207], v[224:227], v[228:231], v[192:207]
  ds_read_b128 v[216:219], v98 offset:800
  ds_read_b64_tr_b16 v[220:221], v97 offset:45056
  ds_read_b64_tr_b16 v[222:223], v97 offset:47104
  s_waitcnt lgkmcnt(6)
  v_mfma_f32_32x32x16_bf16 v[192:207], v[232:235], v[236:239], v[192:207]
  ds_read_b128 v[224:227], v98 offset:832
  ds_read_b64_tr_b16 v[228:229], v97 offset:49152
  ds_read_b64_tr_b16 v[230:231], v97 offset:51200
  s_waitcnt lgkmcnt(6)
  v_mfma_f32_32x32x16_bf16 v[192:207], v[208:211], v[212:215], v[192:207]
  ds_read_b128 v[232:235], v98 offset:864
  ds_read_b64_tr_b16 v[236:237], v97 offset:53248
  ds_read_b64_tr_b16 v[238:239], v97 offset:55296
  s_waitcnt lgkmcnt(6)
  v_mfma_f32_32x32x16_bf16 v[192:207], v[216:219], v[220:223], v[192:207]
  s_waitcnt lgkmcnt(3)
  v_mfma_f32_32x32x16_bf16 v[192:207], v[224:227], v[228:231], v[192:207]
  s_waitcnt lgkmcnt(0)
  v_mfma_f32_32x32x16_bf16 v[192:207], v[232:235], v[236:239], v[192:207]
  s_nop 11
  v_add_f32 v192, v192, v9
  v_cvt_pk_bf16_f32 v193, v192, v192
  v_and_b32 v193, 0xffff0000, v193
  v_sub_f32 v194, v192, v193
  v_cvt_pk_bf16_f32 v194, v193, v194
  v_mov_b32 v195, s6
  buffer_store_dwordx2 v[194:195], v245, s[48:51], s64 offen sc1
L_nouv:
  s_lshl4_add_u32 s61, s4, s5
  s_cmp_lg_u32 s61, 254
  s_cbranch_scc1 L_noe
  v_lshlrev_b32 v240, 7, v0
  s_lshl_b32 s70, s3, 22
  s_add_u32 s70, s70, 3080192
  s_add_u32 s71, s70, 1048576
  s_add_u32 s72, s70, 2097152
  s_add_u32 s73, s70, 3145728
  s_mov_b32 s68, 0
L_poll_28:
  buffer_load_dword v241, v240, s[48:51], s70 offen sc1
  buffer_load_dword v242, v240, s[48:51], s71 offen sc1
  buffer_load_dword v243, v240, s[48:51], s72 offen sc1
  buffer_load_dword v244, v240, s[48:51], s73 offen sc1
  s_add_u32 s68, s68, 1
  s_cmp_ge_u32 s68, 1048576
  s_cbranch_scc1 L_end
  s_waitcnt vmcnt(0)
  v_xor_b32 v245, s6, v241
  v_xor_b32 v246, s6, v242
  v_or_b32 v245, v245, v246
  v_xor_b32 v246, s6, v243
  v_or_b32 v245, v245, v246
  v_xor_b32 v246, s6, v244
  v_or_b32 v245, v245, v246
  v_cmp_ne_u32 vcc, 0, v245
  s_nop 0
  s_cmp_lg_u64 vcc, 0
  s_cbranch_scc1 L_poll_28
  s_barrier
  s_cmp_lg_u32 s3, 0
  s_cbranch_scc1 L_noe
  s_mov_b64 exec, 1
  buffer_store_dword v3, off, s[48:51], 0 offset:0 sc1
  s_mov_b64 exec, -1
L_noe:
  s_and_b32 s62, s5, 1
  s_lshl2_add_u32 s62, s62, s3
  s_and_b32 s63, s4, 1
  s_lshl3_add_u32 s63, s63, s62
  v_lshlrev_b32 v240, 7, v0
  s_mul_i32 s63, s63, 114688
  s_add_u32 s63, s63, 17024
  s_mul_i32 s62, s62, 57344
  s_add_u32 s62, s62, s60
  s_add_u32 s62, s62, 524288
  buffer_load_dword v241, v240, s[28:31], s63 offen
  s_add_u32 s63, s63, 8192
  buffer_load_dword v241, v240, s[28:31], s63 offen
  s_add_u32 s63, s63, 8192
  buffer_load_dword v241, v240, s[28:31], s63 offen
  s_add_u32 s63, s63, 8192
  buffer_load_dword v241, v240, s[28:31], s63 offen
  s_add_u32 s63, s63, 8192
  buffer_load_dword v241, v240, s[28:31], s63 offen
  s_add_u32 s63, s63, 8192
  buffer_load_dword v241, v240, s[28:31], s63 offen
  s_add_u32 s63, s63, 8192
  buffer_load_dword v241, v240, s[28:31], s63 offen
  s_add_u32 s63, s63, 8192
  buffer_load_dword v241, v240, s[28:31], s63 offen
  s_add_u32 s63, s63, 8192
  buffer_load_dword v241, v240, s[28:31], s63 offen
  s_add_u32 s63, s63, 8192
  buffer_load_dword v241, v240, s[28:31], s63 offen
  s_add_u32 s63, s63, 8192
  buffer_load_dword v241, v240, s[28:31], s63 offen
  s_add_u32 s63, s63, 8192
  buffer_load_dword v241, v240, s[28:31], s63 offen
  s_add_u32 s63, s63, 8192
  s_waitcnt vmcnt(0)
  v_min_u32 v244, 6, v0
  v_lshlrev_b32 v244, 3, v244
  s_and_b32 s61, s5, 1
  s_lshl4_add_u32 s70, s3, s61
  s_lshl2_add_u32 s70, s70, s60
  s_add_u32 s70, s70, 523264
  s_mov_b32 s68, 0
L_poll_29:
  buffer_load_dword v245, v244, s[48:51], s70 offen offset:0 sc1
  s_add_u32 s68, s68, 1
  s_cmp_ge_u32 s68, 1048576
  s_cbranch_scc1 L_end
  s_waitcnt vmcnt(0)
  v_cmp_ne_u32 vcc, s6, v245
  s_nop 0
  s_cmp_lg_u64 vcc, 0
  s_cbranch_scc1 L_poll_29
  s_mul_i32 s64, s3, 114688
  s_and_b32 s61, s5, 1
  s_mul_i32 s65, s61, 8192
  s_add_u32 s64, s64, s65
  s_xor_b32 s61, s61, 0
  s_lshl_b32 s61, s61, 11
  s_add_u32 s64, s64, s61
  s_add_u32 s64, s64, s60
  s_add_u32 s64, s64, 524288
  v_lshrrev_b32 v242, 4, v0
  v_lshlrev_b32 v242, 14, v242
  v_and_b32 v243, 15, v0
  v_lshl_add_u32 v242, v243, 7, v242
  buffer_load_dword v241, v242, s[48:51], s64 offen sc1
  s_add_u32 s64, s64, 65536
  s_lshr_b64 exec, -1, 16
  buffer_load_dword v241, v242, s[48:51], s64 offen sc1
  s_mov_b64 exec, -1
  s_mov_b32 s68, 0
L_poll_30:
  buffer_load_dword v245, v244, s[48:51], s70 offen offset:256 sc1
  s_add_u32 s68, s68, 1
  s_cmp_ge_u32 s68, 1048576
  s_cbranch_scc1 L_end
  s_waitcnt vmcnt(0)
  v_cmp_ne_u32 vcc, s6, v245
  s_nop 0
  s_cmp_lg_u64 vcc, 0
  s_cbranch_scc1 L_poll_30
  s_mul_i32 s64, s3, 114688
  s_and_b32 s61, s5, 1
  s_mul_i32 s65, s61, 8192
  s_add_u32 s64, s64, s65
  s_xor_b32 s61, s61, 1
  s_lshl_b32 s61, s61, 11
  s_add_u32 s64, s64, s61
  s_add_u32 s64, s64, s60
  s_add_u32 s64, s64, 524288
  v_lshrrev_b32 v242, 4, v0
  v_lshlrev_b32 v242, 14, v242
  v_and_b32 v243, 15, v0
  v_lshl_add_u32 v242, v243, 7, v242
  buffer_load_dword v241, v242, s[48:51], s64 offen sc1
  s_add_u32 s64, s64, 65536
  s_lshr_b64 exec, -1, 16
  buffer_load_dword v241, v242, s[48:51], s64 offen sc1
  s_mov_b64 exec, -1
  s_mov_b32 s68, 0
L_poll_31:
  buffer_load_dword v245, v244, s[48:51], s70 offen offset:512 sc1
  s_add_u32 s68, s68, 1
  s_cmp_ge_u32 s68, 1048576
  s_cbranch_scc1 L_end
  s_waitcnt vmcnt(0)
  v_cmp_ne_u32 vcc, s6, v245
  s_nop 0
  s_cmp_lg_u64 vcc, 0
  s_cbranch_scc1 L_poll_31
  s_mul_i32 s64, s3, 114688
  s_and_b32 s61, s5, 1
  s_mul_i32 s65, s61, 8192
  s_add_u32 s64, s64, s65
  s_xor_b32 s61, s61, 0
  s_lshl_b32 s61, s61, 11
  s_add_u32 s64, s64, s61
  s_add_u32 s64, s64, s60
  s_add_u32 s64, s64, 528384
  v_lshrrev_b32 v242, 4, v0
  v_lshlrev_b32 v242, 14, v242
  v_and_b32 v243, 15, v0
  v_lshl_add_u32 v242, v243, 7, v242
  buffer_load_dword v241, v242, s[48:51], s64 offen sc1
  s_add_u32 s64, s64, 65536
  s_lshr_b64 exec, -1, 16
  buffer_load_dword v241, v242, s[48:51], s64 offen sc1
  s_mov_b64 exec, -1
  s_waitcnt vmcnt(0)
  s_cmp_lg_u32 s3, 0
  s_cbranch_scc1 L_end
L_end:
L_exit:
  s_endpgm
L_chk_2:
  s_mov_b32 s68, 0
L_chk_2l:
  buffer_load_dwordx2 v[56:57], v241, s[48:51], s64 offen sc1
  s_add_u32 s68, s68, 1
  s_cmp_ge_u32 s68, 1048576
  s_cbranch_scc1 L_end
  s_waitcnt vmcnt(0)
  v_cmp_ne_u32 vcc, s6, v57
  s_nop 1
  s_cmp_lg_u64 vcc, 0
  s_cbranch_scc1 L_chk_2l
  s_branch L_chk_2r
L_rel_3:
  buffer_wbl2 sc1
  s_waitcnt vmcnt(0)
  buffer_store_dword v3, off, s[48:51], s72 offset:0 sc1
  s_branch L_rel_3r
L_chk_4:
  s_mov_b32 s68, 0
L_chk_4l:
  buffer_load_dwordx2 v[56:57], v241, s[48:51], s64 offen sc1
  s_add_u32 s68, s68, 1
  s_cmp_ge_u32 s68, 1048576
  s_cbranch_scc1 L_end
  s_waitcnt vmcnt(0)
  v_cmp_ne_u32 vcc, s6, v57
  s_nop 1
  s_cmp_lg_u64 vcc, 0
  s_cbranch_scc1 L_chk_4l
  s_branch L_chk_4r
L_acq_7:
  buffer_inv sc1
  s_waitcnt vmcnt(0)
  s_branch L_acq_7r
L_hs3:
  v_lshrrev_b32 v56, 4, v0
  v_bfe_u32 v57, v0, 2, 2
  v_lshl_add_u32 v57, v56, 3, v57
  v_lshlrev_b32 v57, 7, v57
  v_and_b32 v58, 3, v0
  v_lshl_add_u32 v57, v58, 3, v57
  v_bfe_u32 v58, v0, 3, 1
  v_lshl_add_u32 v57, v58, 6, v57
  s_lshl_b32 s40, s3, 5
  v_xor_b32 v57, s40, v57
  v_add_u32 v58, 86016, v57
  v_add_u32 v57, 114688, v57
  v_lshlrev_b32 v56, 4, v56
  v_add_u32 v59, 160256, v56
  ds_read_b128 a[0:3], v59 offset:0
  ds_read_b64_tr_b16 a[4:5], v58 offset:0
  ds_read_b64_tr_b16 a[6:7], v58 offset:512
  ds_read_b128 a[8:11], v59 offset:64
  ds_read_b64_tr_b16 a[12:13], v58 offset:4096
  ds_read_b64_tr_b16 a[14:15], v58 offset:4608
  ds_read_b128 a[16:19], v59 offset:128
  ds_read_b64_tr_b16 a[20:21], v58 offset:8192
  ds_read_b64_tr_b16 a[22:23], v58 offset:8704
  ds_read_b128 a[24:27], v59 offset:192
  ds_read_b64_tr_b16 a[28:29], v58 offset:12288
  ds_read_b64_tr_b16 a[30:31], v58 offset:12800
  s_waitcnt lgkmcnt(9)
  v_mfma_f32_16x16x32_bf16 v[224:227], a[4:7], a[0:3], 0
  ds_read_b128 a[32:35], v59 offset:256
  ds_read_b64_tr_b16 a[36:37], v58 offset:16384
  ds_read_b64_tr_b16 a[38:39], v58 offset:16896
  s_waitcnt lgkmcnt(9)
  v_mfma_f32_16x16x32_bf16 v[228:231], a[12:15], a[8:11], 0
  ds_read_b128 a[40:43], v59 offset:320
  ds_read_b64_tr_b16 a[44:45], v58 offset:20480
  ds_read_b64_tr_b16 a[46:47], v58 offset:20992
  s_waitcnt lgkmcnt(9)
  v_mfma_f32_16x16x32_bf16 v[224:227], a[20:23], a[16:19], v[224:227]
  ds_read_b128 a[48:51], v59 offset:384
  ds_read_b64_tr_b16 a[52:53], v58 offset:24576
  ds_read_b64_tr_b16 a[54:55], v58 offset:25088
  s_waitcnt lgkmcnt(9)
  v_mfma_f32_16x16x32_bf16 v[228:231], a[28:31], a[24:27], v[228:231]
  ds_read_b128 a[56:59], v59 offset:448
  ds_read_b64_tr_b16 a[60:61], v57 offset:0
  ds_read_b64_tr_b16 a[62:63], v57 offset:512
  s_waitcnt lgkmcnt(9)
  v_mfma_f32_16x16x32_bf16 v[224:227], a[36:39], a[32:35], v[224:227]
  ds_read_b128 a[64:67], v59 offset:512
  ds_read_b64_tr_b16 a[68:69], v57 offset:4096
  ds_read_b64_tr_b16 a[70:71], v57 offset:4608
  s_waitcnt lgkmcnt(9)
  v_mfma_f32_16x16x32_bf16 v[228:231], a[44:47], a[40:43], v[228:231]
  ds_read_b128 a[72:75], v59 offset:576
  ds_read_b64_tr_b16 a[76:77], v57 offset:8192
  ds_read_b64_tr_b16 a[78:79], v57 offset:8704
  s_waitcnt lgkmcnt(9)
  v_mfma_f32_16x16x32_bf16 v[224:227], a[52:55], a[48:51], v[224:227]
  ds_read_b128 a[80:83], v59 offset:640
  ds_read_b64_tr_b16 a[84:85], v57 offset:12288
  ds_read_b64_tr_b16 a[86:87], v57 offset:12800
  s_waitcnt lgkmcnt(9)
  v_mfma_f32_16x16x32_bf16 v[228:231], a[60:63], a[56:59], v[228:231]
  ds_read_b128 a[88:91], v59 offset:704
  ds_read_b64_tr_b16 a[92:93], v57 offset:16384
  ds_read_b64_tr_b16 a[94:95], v57 offset:16896
  s_waitcnt lgkmcnt(9)
  v_mfma_f32_16x16x32_bf16 v[224:227], a[68:71], a[64:67], v[224:227]
  ds_read_b128 a[96:99], v59 offset:768
  ds_read_b64_tr_b16 a[100:101], v57 offset:20480
  ds_read_b64_tr_b16 a[102:103], v57 offset:20992
  s_waitcnt lgkmcnt(9)
  v_mfma_f32_16x16x32_bf16 v[228:231], a[76:79], a[72:75], v[228:231]
  ds_read_b128 a[104:107], v59 offset:832
  ds_read_b64_tr_b16 a[108:109], v57 offset:24576
  ds_read_b64_tr_b16 a[110:111], v57 offset:25088
  s_waitcnt lgkmcnt(9)
  v_mfma_f32_16x16x32_bf16 v[224:227], a[84:87], a[80:83], v[224:227]
  s_waitcnt lgkmcnt(6)
  v_mfma_f32_16x16x32_bf16 v[228:231], a[92:95], a[88:91], v[228:231]
  s_waitcnt lgkmcnt(3)
  v_mfma_f32_16x16x32_bf16 v[224:227], a[100:103], a[96:99], v[224:227]
  s_waitcnt lgkmcnt(0)
  v_mfma_f32_16x16x32_bf16 v[228:231], a[108:111], a[104:107], v[228:231]
  s_mul_i32 s41, s58, 37
  s_lshr_b32 s41, s41, 8
  s_cmp_eq_u32 s41, 4
  s_cselect_b32 s40, 1.0, 0
  s_add_u32 s41, s41, s58
  s_lshl2_add_u32 s41, s41, s3
  s_lshl_b32 s41, s41, 6
  s_add_u32 s41, s41, 8192
  v_mov_b32 v234, s6
  v_mov_b32 v235, s6
  v_pk_add_f32 v[224:225], v[224:225], v[228:229]
  v_pk_add_f32 v[226:227], v[226:227], v[230:231]
  v_cvt_pk_bf16_f32 v232, v224, v225
  v_cvt_pk_bf16_f32 v233, v226, v227
  v_lshlrev_b32 v224, 16, v232
  v_and_b32 v225, 0xffff0000, v232
  v_lshlrev_b32 v226, 16, v233
  v_and_b32 v227, 0xffff0000, v233
  v_add_f32 v224, s40, v224
  v_add_f32 v225, s40, v225
  v_add_f32 v226, s40, v226
  v_add_f32 v227, s40, v227
  v_cvt_pk_bf16_f32 v232, v224, v225
  v_cvt_pk_bf16_f32 v233, v226, v227
  s_mov_b32 exec_lo, 0x00010001
  s_mov_b32 exec_hi, 0x00010001
  buffer_store_dwordx4 v[232:235], v56, s[48:51], s41 offen sc1
  s_mov_b64 exec, -1
  s_barrier
  s_branch L_hs3r
L_rel_10:
  buffer_wbl2 sc1
  s_waitcnt vmcnt(0)
  buffer_store_dword v3, off, s[48:51], s74 offset:0 sc1
  s_branch L_rel_10r
L_chk_11:
  s_mov_b32 s68, 0
L_chk_11l:
  buffer_load_dwordx4 v[56:59], v253, s[48:51], s56 offen offset:0 sc1
  buffer_load_dwordx4 v[60:63], v253, s[48:51], s56 offen offset:896 sc1
  s_add_u32 s68, s68, 1
  s_cmp_ge_u32 s68, 1048576
  s_cbranch_scc1 L_end
  s_waitcnt vmcnt(0)
  v_xor_b32 v64, s6, v58
  v_xor_b32 v65, s6, v62
  v_or_b32 v64, v64, v65
  v_cmp_ne_u32 vcc, 0, v64
  s_nop 1
  s_cmp_lg_u64 vcc, 0
  s_cbranch_scc1 L_chk_11l
  s_branch L_chk_11r
L_acq_13:
  buffer_inv sc1
  s_waitcnt vmcnt(0)
  s_branch L_acq_13r
L_rel_14:
  buffer_wbl2 sc1
  s_waitcnt vmcnt(0)
  buffer_store_dword v3, off, s[48:51], s72 offset:0 sc1
  s_branch L_rel_14r
L_acq_16:
  buffer_inv sc1
  s_waitcnt vmcnt(0)
  s_branch L_acq_16r
L_rel_17:
  buffer_wbl2 sc1
  s_waitcnt vmcnt(0)
  buffer_store_dword v3, v254, s[48:51], s8 offen offset:0 sc1
  s_branch L_rel_17r
L_rel_19:
  buffer_wbl2 sc1
  s_waitcnt vmcnt(0)
  buffer_store_dword v3, v254, s[48:51], s8 offen offset:256 sc1
  s_branch L_rel_19r
L_chk_20:
  s_mov_b32 s68, 0
L_chk_20l:
  buffer_load_dword v241, v249, s[48:51], s10 offen offset:256 sc1
  s_add_u32 s68, s68, 1
  s_cmp_ge_u32 s68, 1048576
  s_cbranch_scc1 L_end
  s_waitcnt vmcnt(0)
  v_cmp_ne_u32 vcc, s6, v241
  s_nop 1
  s_cmp_lg_u64 vcc, 0
  s_cbranch_scc1 L_chk_20l
  s_cmp_eq_u32 s7, 0
  s_cbranch_scc1 L_chk_20r
  buffer_inv sc1
  s_waitcnt vmcnt(0)
  s_branch L_chk_20r
L_rel_21:
  buffer_wbl2 sc1
  s_waitcnt vmcnt(0)
  buffer_store_dword v3, v254, s[48:51], s8 offen offset:512 sc1
  s_branch L_rel_21r
L_chk_22:
  s_mov_b32 s68, 0
L_chk_22l:
  buffer_load_dword v241, v249, s[48:51], s10 offen offset:512 sc1
  s_add_u32 s68, s68, 1
  s_cmp_ge_u32 s68, 1048576
  s_cbranch_scc1 L_end
  s_waitcnt vmcnt(0)
  v_cmp_ne_u32 vcc, s6, v241
  s_nop 1
  s_cmp_lg_u64 vcc, 0
  s_cbranch_scc1 L_chk_22l
  s_cmp_eq_u32 s7, 0
  s_cbranch_scc1 L_chk_22r
  buffer_inv sc1
  s_waitcnt vmcnt(0)
  s_branch L_chk_22r
L_rel_23:
  buffer_wbl2 sc1
  s_waitcnt vmcnt(0)
  buffer_store_dword v3, v254, s[48:51], s8 offen offset:768 sc1
  s_branch L_rel_23r
L_chk_25:
  s_mov_b32 s68, 0
L_chk_25l:
  buffer_load_dwordx2 v[16:17], v245, s[48:51], s56 offen offset:0 sc1
  buffer_load_dwordx2 v[18:19], v245, s[48:51], s56 offen offset:512 sc1
  buffer_load_dwordx2 v[20:21], v245, s[48:51], s56 offen offset:1024 sc1
  buffer_load_dwordx2 v[22:23], v245, s[48:51], s56 offen offset:1536 sc1
  s_add_u32 s68, s68, 1
  s_cmp_ge_u32 s68, 1048576
  s_cbranch_scc1 L_end
  s_waitcnt vmcnt(0)
  v_xor_b32 v246, s6, v17
  v_xor_b32 v247, s6, v19
  v_or_b32 v246, v246, v247
  v_xor_b32 v247, s6, v21
  v_or_b32 v246, v246, v247
  v_xor_b32 v247, s6, v23
  v_or_b32 v246, v246, v247
  v_cmp_ne_u32 vcc, 0, v246
  s_nop 1
  s_cmp_lg_u64 vcc, 0
  s_cbranch_scc1 L_chk_25l
  s_branch L_chk_25r
L_rel_26:
  buffer_wbl2 sc1
  s_waitcnt vmcnt(0)
  buffer_store_dword v3, off, s[48:51], s74 offset:0 sc1
  s_branch L_rel_26r
L_hotend:
L_p2slow:
  s_waitcnt vmcnt(0) lgkmcnt(0)
  s_nop 7
  v_mov_b32 v250, 0x3f80
  v_cndmask_b32 v38, v38, v250, s[62:63]
  v_cndmask_b32 v39, v39, v246, s[62:63]
  v_mfma_f32_32x32x16_bf16 v[128:143], v[40:43], v[32:35], v[208:223]
  s_nop 0
  v_mfma_f32_32x32x16_bf16 v[128:143], v[44:47], v[36:39], v[128:143]
  s_nop 11
  v_max_f32 v240, v128, v129
  v_max_f32 v241, v130, v131
  v_max3_f32 v240, v132, v133, v240
  v_max3_f32 v241, v134, v135, v241
  v_max3_f32 v240, v136, v137, v240
  v_max3_f32 v241, v138, v139, v241
  v_max3_f32 v240, v140, v141, v240
  v_max3_f32 v241, v142, v143, v241
  ds_read_b128 v[104:107], v6 offset:28672
  ds_read_b128 v[108:111], v6 offset:29696
  s_waitcnt lgkmcnt(1)
  v_mfma_f32_32x32x16_bf16 v[128:143], v[104:107], v[32:35], 0
  s_waitcnt lgkmcnt(0)
  v_mfma_f32_32x32x16_bf16 v[128:143], v[108:111], v[36:39], v[128:143]
  s_nop 11
  v_max3_f32 v240, v128, v129, v240
  v_max3_f32 v241, v130, v131, v241
  v_max3_f32 v240, v132, v133, v240
  v_max3_f32 v241, v134, v135, v241
  v_max3_f32 v240, v136, v137, v240
  v_max3_f32 v241, v138, v139, v241
  v_max3_f32 v240, v140, v141, v240
  v_max3_f32 v241, v142, v143, v241
  ds_read_b128 v[112:115], v6 offset:24576
  ds_read_b128 v[116:119], v6 offset:25600
  s_waitcnt lgkmcnt(1)
  v_mfma_f32_32x32x16_bf16 v[128:143], v[112:115], v[32:35], 0
  s_waitcnt lgkmcnt(0)
  v_mfma_f32_32x32x16_bf16 v[128:143], v[116:119], v[36:39], v[128:143]
  s_nop 11
  v_max3_f32 v240, v128, v129, v240
  v_max3_f32 v241, v130, v131, v241
  v_max3_f32 v240, v132, v133, v240
  v_max3_f32 v241, v134, v135, v241
  v_max3_f32 v240, v136, v137, v240
  v_max3_f32 v241, v138, v139, v241
  v_max3_f32 v240, v140, v141, v240
  v_max3_f32 v241, v142, v143, v241
  ds_read_b128 v[96:99], v6 offset:20480
  ds_read_b128 v[100:103], v6 offset:21504
  s_waitcnt lgkmcnt(1)
  v_mfma_f32_32x32x16_bf16 v[128:143], v[96:99], v[32:35], 0
  s_waitcnt lgkmcnt(0)
  v_mfma_f32_32x32x16_bf16 v[128:143], v[100:103], v[36:39], v[128:143]
  s_nop 11
  v_max3_f32 v240, v128, v129, v240
  v_max3_f32 v241, v130, v131, v241
  v_max3_f32 v240, v132, v133, v240
  v_max3_f32 v241, v134, v135, v241
  v_max3_f32 v240, v136, v137, v240
  v_max3_f32 v241, v138, v139, v241
  v_max3_f32 v240, v140, v141, v240
  v_max3_f32 v241, v142, v143, v241
  ds_read_b128 v[104:107], v6 offset:16384
  ds_read_b128 v[108:111], v6 offset:17408
  s_waitcnt lgkmcnt(1)
  v_mfma_f32_32x32x16_bf16 v[128:143], v[104:107], v[32:35], 0
  s_waitcnt lgkmcnt(0)
  v_mfma_f32_32x32x16_bf16 v[128:143], v[108:111], v[36:39], v[128:143]
  s_nop 11
  v_max3_f32 v240, v128, v129, v240
  v_max3_f32 v241, v130, v131, v241
  v_max3_f32 v240, v132, v133, v240
  v_max3_f32 v241, v134, v135, v241
  v_max3_f32 v240, v136, v137, v240
  v_max3_f32 v241, v138, v139, v241
  v_max3_f32 v240, v140, v141, v240
  v_max3_f32 v241, v142, v143, v241
  ds_read_b128 v[112:115], v6 offset:12288
  ds_read_b128 v[116:119], v6 offset:13312
  s_waitcnt lgkmcnt(1)
  v_mfma_f32_32x32x16_bf16 v[128:143], v[112:115], v[32:35], 0
  s_waitcnt lgkmcnt(0)
  v_mfma_f32_32x32x16_bf16 v[128:143], v[116:119], v[36:39], v[128:143]
  s_nop 11
  v_max3_f32 v240, v128, v129, v240
  v_max3_f32 v241, v130, v131, v241
  v_max3_f32 v240, v132, v133, v240
  v_max3_f32 v241, v134, v135, v241
  v_max3_f32 v240, v136, v137, v240
  v_max3_f32 v241, v138, v139, v241
  v_max3_f32 v240, v140, v141, v240
  v_max3_f32 v241, v142, v143, v241
  ds_read_b128 v[96:99], v6 offset:8192
  ds_read_b128 v[100:103], v6 offset:9216
  s_waitcnt lgkmcnt(1)
  v_mfma_f32_32x32x16_bf16 v[128:143], v[96:99], v[32:35], 0
  s_waitcnt lgkmcnt(0)
  v_mfma_f32_32x32x16_bf16 v[128:143], v[100:103], v[36:39], v[128:143]
  s_nop 11
  v_max3_f32 v240, v128, v129, v240
  v_max3_f32 v241, v130, v131, v241
  v_max3_f32 v240, v132, v133, v240
  v_max3_f32 v241, v134, v135, v241
  v_max3_f32 v240, v136, v137, v240
  v_max3_f32 v241, v138, v139, v241
  v_max3_f32 v240, v140, v141, v240
  v_max3_f32 v241, v142, v143, v241
  ds_read_b128 v[104:107], v6 offset:4096
  ds_read_b128 v[108:111], v6 offset:5120
  s_waitcnt lgkmcnt(1)
  v_mfma_f32_32x32x16_bf16 v[128:143], v[104:107], v[32:35], 0
  s_waitcnt lgkmcnt(0)
  v_mfma_f32_32x32x16_bf16 v[128:143], v[108:111], v[36:39], v[128:143]
  s_nop 11
  v_max3_f32 v240, v128, v129, v240
  v_max3_f32 v241, v130, v131, v241
  v_max3_f32 v240, v132, v133, v240
  v_max3_f32 v241, v134, v135, v241
  v_max3_f32 v240, v136, v137, v240
  v_max3_f32 v241, v138, v139, v241
  v_max3_f32 v240, v140, v141, v240
  v_max3_f32 v241, v142, v143, v241
  ds_read_b128 v[112:115], v6 offset:0
  ds_read_b128 v[116:119], v6 offset:1024
  s_waitcnt lgkmcnt(1)
  v_mfma_f32_32x32x16_bf16 v[128:143], v[112:115], v[32:35], v[192:207]
  s_waitcnt lgkmcnt(0)
  v_mfma_f32_32x32x16_bf16 v[128:143], v[116:119], v[36:39], v[128:143]
  s_nop 11
  v_max3_f32 v240, v128, v129, v240
  v_max3_f32 v241, v130, v131, v241
  v_max3_f32 v240, v132, v133, v240
  v_max3_f32 v241, v134, v135, v241
  v_max3_f32 v240, v136, v137, v240
  v_max3_f32 v241, v138, v139, v241
  v_max3_f32 v240, v140, v141, v240
  v_max3_f32 v241, v142, v143, v241
  v_max_f32 v240, v240, v241
  v_mov_b32 v241, v240
  s_nop 1
  v_permlane32_swap_b32 v240, v241
  v_max_f32 v240, v240, v241
  v_xor_b32 v240, 0x80000000, v240
  v_and_b32 v241, 0xffff0000, v240
  v_sub_f32 v240, v240, v241
  v_and_b32 v242, 0xffff0000, v240
  v_sub_f32 v240, v240, v242
  v_or_b32 v241, 0x3f80, v241
  v_cvt_pk_bf16_f32 v240, v242, v240
  v_cndmask_b32 v38, v38, v241, s[62:63]
  v_cndmask_b32 v39, v39, v240, s[62:63]
  v_mfma_f32_32x32x16_bf16 v[128:143], v[40:43], v[32:35], v[208:223]
  s_nop 0
  v_mfma_f32_32x32x16_bf16 v[128:143], v[44:47], v[36:39], v[128:143]
  s_nop 11
  v_exp_f32 v128, v128
  v_exp_f32 v129, v129
  v_exp_f32 v130, v130
  v_exp_f32 v131, v131
  v_exp_f32 v132, v132
  v_exp_f32 v133, v133
  v_exp_f32 v134, v134
  v_exp_f32 v135, v135
  v_cvt_pk_bf16_f32 v160, v128, v129
  v_cvt_pk_bf16_f32 v161, v130, v131
  v_exp_f32 v136, v136
  v_exp_f32 v137, v137
  v_exp_f32 v138, v138
  v_exp_f32 v139, v139
  v_cvt_pk_bf16_f32 v162, v132, v133
  v_cvt_pk_bf16_f32 v163, v134, v135
  v_exp_f32 v140, v140
  v_exp_f32 v141, v141
  v_exp_f32 v142, v142
  v_exp_f32 v143, v143
  v_cvt_pk_bf16_f32 v164, v136, v137
  v_cvt_pk_bf16_f32 v165, v138, v139
  v_cvt_pk_bf16_f32 v166, v140, v141
  v_cvt_pk_bf16_f32 v167, v142, v143
  v_mfma_f32_32x32x16_bf16 v[176:191], v[48:51], v[160:163], 0
  s_nop 0
  v_mfma_f32_32x32x16_bf16 v[176:191], v[52:55], v[164:167], v[176:191]
  ds_read_b128 v[104:107], v6 offset:28672
  ds_read_b128 v[108:111], v6 offset:29696
  ds_read_b128 v[232:235], v6 offset:30720
  ds_read_b128 v[236:239], v6 offset:31744
  s_waitcnt lgkmcnt(3)
  v_mfma_f32_32x32x16_bf16 v[144:159], v[104:107], v[32:35], 0
  s_waitcnt lgkmcnt(2)
  v_mfma_f32_32x32x16_bf16 v[144:159], v[108:111], v[36:39], v[144:159]
  s_nop 11
  v_exp_f32 v144, v144
  v_exp_f32 v145, v145
  v_exp_f32 v146, v146
  v_exp_f32 v147, v147
  v_exp_f32 v148, v148
  v_exp_f32 v149, v149
  v_exp_f32 v150, v150
  v_exp_f32 v151, v151
  v_cvt_pk_bf16_f32 v168, v144, v145
  v_cvt_pk_bf16_f32 v169, v146, v147
  v_exp_f32 v152, v152
  v_exp_f32 v153, v153
  v_exp_f32 v154, v154
  v_exp_f32 v155, v155
  v_cvt_pk_bf16_f32 v170, v148, v149
  v_cvt_pk_bf16_f32 v171, v150, v151
  v_exp_f32 v156, v156
  v_exp_f32 v157, v157
  v_exp_f32 v158, v158
  v_exp_f32 v159, v159
  v_cvt_pk_bf16_f32 v172, v152, v153
  v_cvt_pk_bf16_f32 v173, v154, v155
  v_cvt_pk_bf16_f32 v174, v156, v157
  v_cvt_pk_bf16_f32 v175, v158, v159
  s_waitcnt lgkmcnt(1)
  v_mfma_f32_32x32x16_bf16 v[176:191], v[232:235], v[168:171], v[176:191]
  s_waitcnt lgkmcnt(0)
  v_mfma_f32_32x32x16_bf16 v[176:191], v[236:239], v[172:175], v[176:191]
  ds_read_b128 v[112:115], v6 offset:24576
  ds_read_b128 v[116:119], v6 offset:25600
  ds_read_b128 v[224:227], v6 offset:26624
  ds_read_b128 v[228:231], v6 offset:27648
  s_waitcnt lgkmcnt(3)
  v_mfma_f32_32x32x16_bf16 v[128:143], v[112:115], v[32:35], 0
  s_waitcnt lgkmcnt(2)
  v_mfma_f32_32x32x16_bf16 v[128:143], v[116:119], v[36:39], v[128:143]
  s_nop 11
  v_exp_f32 v128, v128
  v_exp_f32 v129, v129
  v_exp_f32 v130, v130
  v_exp_f32 v131, v131
  v_exp_f32 v132, v132
  v_exp_f32 v133, v133
  v_exp_f32 v134, v134
  v_exp_f32 v135, v135
  v_cvt_pk_bf16_f32 v160, v128, v129
  v_cvt_pk_bf16_f32 v161, v130, v131
  v_exp_f32 v136, v136
  v_exp_f32 v137, v137
  v_exp_f32 v138, v138
  v_exp_f32 v139, v139
  v_cvt_pk_bf16_f32 v162, v132, v133
  v_cvt_pk_bf16_f32 v163, v134, v135
  v_exp_f32 v140, v140
  v_exp_f32 v141, v141
  v_exp_f32 v142, v142
  v_exp_f32 v143, v143
  v_cvt_pk_bf16_f32 v164, v136, v137
  v_cvt_pk_bf16_f32 v165, v138, v139
  v_cvt_pk_bf16_f32 v166, v140, v141
  v_cvt_pk_bf16_f32 v167, v142, v143
  s_waitcnt lgkmcnt(1)
  v_mfma_f32_32x32x16_bf16 v[176:191], v[224:227], v[160:163], v[176:191]
  s_waitcnt lgkmcnt(0)
  v_mfma_f32_32x32x16_bf16 v[176:191], v[228:231], v[164:167], v[176:191]
  ds_read_b128 v[96:99], v6 offset:20480
  ds_read_b128 v[100:103], v6 offset:21504
  ds_read_b128 v[232:235], v6 offset:22528
  ds_read_b128 v[236:239], v6 offset:23552
  s_waitcnt lgkmcnt(3)
  v_mfma_f32_32x32x16_bf16 v[144:159], v[96:99], v[32:35], 0
  s_waitcnt lgkmcnt(2)
  v_mfma_f32_32x32x16_bf16 v[144:159], v[100:103], v[36:39], v[144:159]
  s_nop 11
  v_exp_f32 v144, v144
  v_exp_f32 v145, v145
  v_exp_f32 v146, v146
  v_exp_f32 v147, v147
  v_exp_f32 v148, v148
  v_exp_f32 v149, v149
  v_exp_f32 v150, v150
  v_exp_f32 v151, v151
  v_cvt_pk_bf16_f32 v168, v144, v145
  v_cvt_pk_bf16_f32 v169, v146, v147
  v_exp_f32 v152, v152
  v_exp_f32 v153, v153
  v_exp_f32 v154, v154
  v_exp_f32 v155, v155
  v_cvt_pk_bf16_f32 v170, v148, v149
  v_cvt_pk_bf16_f32 v171, v150, v151
  v_exp_f32 v156, v156
  v_exp_f32 v157, v157
  v_exp_f32 v158, v158
  v_exp_f32 v159, v159
  v_cvt_pk_bf16_f32 v172, v152, v153
  v_cvt_pk_bf16_f32 v173, v154, v155
  v_cvt_pk_bf16_f32 v174, v156, v157
  v_cvt_pk_bf16_f32 v175, v158, v159
  s_waitcnt lgkmcnt(1)
  v_mfma_f32_32x32x16_bf16 v[176:191], v[232:235], v[168:171], v[176:191]
  s_waitcnt lgkmcnt(0)
  v_mfma_f32_32x32x16_bf16 v[176:191], v[236:239], v[172:175], v[176:191]
  ds_read_b128 v[104:107], v6 offset:16384
  ds_read_b128 v[108:111], v6 offset:17408
  ds_read_b128 v[224:227], v6 offset:18432
  ds_read_b128 v[228:231], v6 offset:19456
  s_waitcnt lgkmcnt(3)
  v_mfma_f32_32x32x16_bf16 v[128:143], v[104:107], v[32:35], 0
  s_waitcnt lgkmcnt(2)
  v_mfma_f32_32x32x16_bf16 v[128:143], v[108:111], v[36:39], v[128:143]
  s_nop 11
  v_exp_f32 v128, v128
  v_exp_f32 v129, v129
  v_exp_f32 v130, v130
  v_exp_f32 v131, v131
  v_exp_f32 v132, v132
  v_exp_f32 v133, v133
  v_exp_f32 v134, v134
  v_exp_f32 v135, v135
  v_cvt_pk_bf16_f32 v160, v128, v129
  v_cvt_pk_bf16_f32 v161, v130, v131
  v_exp_f32 v136, v136
  v_exp_f32 v137, v137
  v_exp_f32 v138, v138
  v_exp_f32 v139, v139
  v_cvt_pk_bf16_f32 v162, v132, v133
  v_cvt_pk_bf16_f32 v163, v134, v135
  v_exp_f32 v140, v140
  v_exp_f32 v141, v141
  v_exp_f32 v142, v142
  v_exp_f32 v143, v143
  v_cvt_pk_bf16_f32 v164, v136, v137
  v_cvt_pk_bf16_f32 v165, v138, v139
  v_cvt_pk_bf16_f32 v166, v140, v141
  v_cvt_pk_bf16_f32 v167, v142, v143
  s_waitcnt lgkmcnt(1)
  v_mfma_f32_32x32x16_bf16 v[176:191], v[224:227], v[160:163], v[176:191]
  s_waitcnt lgkmcnt(0)
  v_mfma_f32_32x32x16_bf16 v[176:191], v[228:231], v[164:167], v[176:191]
  ds_read_b128 v[112:115], v6 offset:12288
  ds_read_b128 v[116:119], v6 offset:13312
  ds_read_b128 v[232:235], v6 offset:14336
  ds_read_b128 v[236:239], v6 offset:15360
  s_waitcnt lgkmcnt(3)
  v_mfma_f32_32x32x16_bf16 v[144:159], v[112:115], v[32:35], 0
  s_waitcnt lgkmcnt(2)
  v_mfma_f32_32x32x16_bf16 v[144:159], v[116:119], v[36:39], v[144:159]
  s_nop 11
  v_exp_f32 v144, v144
  v_exp_f32 v145, v145
  v_exp_f32 v146, v146
  v_exp_f32 v147, v147
  v_exp_f32 v148, v148
  v_exp_f32 v149, v149
  v_exp_f32 v150, v150
  v_exp_f32 v151, v151
  v_cvt_pk_bf16_f32 v168, v144, v145
  v_cvt_pk_bf16_f32 v169, v146, v147
  v_exp_f32 v152, v152
  v_exp_f32 v153, v153
  v_exp_f32 v154, v154
  v_exp_f32 v155, v155
  v_cvt_pk_bf16_f32 v170, v148, v149
  v_cvt_pk_bf16_f32 v171, v150, v151
  v_exp_f32 v156, v156
  v_exp_f32 v157, v157
  v_exp_f32 v158, v158
  v_exp_f32 v159, v159
  v_cvt_pk_bf16_f32 v172, v152, v153
  v_cvt_pk_bf16_f32 v173, v154, v155
  v_cvt_pk_bf16_f32 v174, v156, v157
  v_cvt_pk_bf16_f32 v175, v158, v159
  s_waitcnt lgkmcnt(1)
  v_mfma_f32_32x32x16_bf16 v[176:191], v[232:235], v[168:171], v[176:191]
  s_waitcnt lgkmcnt(0)
  v_mfma_f32_32x32x16_bf16 v[176:191], v[236:239], v[172:175], v[176:191]
  ds_read_b128 v[96:99], v6 offset:8192
  ds_read_b128 v[100:103], v6 offset:9216
  ds_read_b128 v[224:227], v6 offset:10240
  ds_read_b128 v[228:231], v6 offset:11264
  s_waitcnt lgkmcnt(3)
  v_mfma_f32_32x32x16_bf16 v[128:143], v[96:99], v[32:35], 0
  s_waitcnt lgkmcnt(2)
  v_mfma_f32_32x32x16_bf16 v[128:143], v[100:103], v[36:39], v[128:143]
  s_nop 11
  v_exp_f32 v128, v128
  v_exp_f32 v129, v129
  v_exp_f32 v130, v130
  v_exp_f32 v131, v131
  v_exp_f32 v132, v132
  v_exp_f32 v133, v133
  v_exp_f32 v134, v134
  v_exp_f32 v135, v135
  v_cvt_pk_bf16_f32 v160, v128, v129
  v_cvt_pk_bf16_f32 v161, v130, v131
  v_exp_f32 v136, v136
  v_exp_f32 v137, v137
  v_exp_f32 v138, v138
  v_exp_f32 v139, v139
  v_cvt_pk_bf16_f32 v162, v132, v133
  v_cvt_pk_bf16_f32 v163, v134, v135
  v_exp_f32 v140, v140
  v_exp_f32 v141, v141
  v_exp_f32 v142, v142
  v_exp_f32 v143, v143
  v_cvt_pk_bf16_f32 v164, v136, v137
  v_cvt_pk_bf16_f32 v165, v138, v139
  v_cvt_pk_bf16_f32 v166, v140, v141
  v_cvt_pk_bf16_f32 v167, v142, v143
  s_waitcnt lgkmcnt(1)
  v_mfma_f32_32x32x16_bf16 v[176:191], v[224:227], v[160:163], v[176:191]
  s_waitcnt lgkmcnt(0)
  v_mfma_f32_32x32x16_bf16 v[176:191], v[228:231], v[164:167], v[176:191]
  ds_read_b128 v[104:107], v6 offset:4096
  ds_read_b128 v[108:111], v6 offset:5120
  ds_read_b128 v[232:235], v6 offset:6144
  ds_read_b128 v[236:239], v6 offset:7168
  s_waitcnt lgkmcnt(3)
  v_mfma_f32_32x32x16_bf16 v[144:159], v[104:107], v[32:35], 0
  s_waitcnt lgkmcnt(2)
  v_mfma_f32_32x32x16_bf16 v[144:159], v[108:111], v[36:39], v[144:159]
  s_nop 11
  v_exp_f32 v144, v144
  v_exp_f32 v145, v145
  v_exp_f32 v146, v146
  v_exp_f32 v147, v147
  v_exp_f32 v148, v148
  v_exp_f32 v149, v149
  v_exp_f32 v150, v150
  v_exp_f32 v151, v151
  v_cvt_pk_bf16_f32 v168, v144, v145
  v_cvt_pk_bf16_f32 v169, v146, v147
  v_exp_f32 v152, v152
  v_exp_f32 v153, v153
  v_exp_f32 v154, v154
  v_exp_f32 v155, v155
  v_cvt_pk_bf16_f32 v170, v148, v149
  v_cvt_pk_bf16_f32 v171, v150, v151
  v_exp_f32 v156, v156
  v_exp_f32 v157, v157
  v_exp_f32 v158, v158
  v_exp_f32 v159, v159
  v_cvt_pk_bf16_f32 v172, v152, v153
  v_cvt_pk_bf16_f32 v173, v154, v155
  v_cvt_pk_bf16_f32 v174, v156, v157
  v_cvt_pk_bf16_f32 v175, v158, v159
  s_waitcnt lgkmcnt(1)
  v_mfma_f32_32x32x16_bf16 v[176:191], v[232:235], v[168:171], v[176:191]
  s_waitcnt lgkmcnt(0)
  v_mfma_f32_32x32x16_bf16 v[176:191], v[236:239], v[172:175], v[176:191]
  ds_read_b128 v[112:115], v6 offset:0
  ds_read_b128 v[116:119], v6 offset:1024
  ds_read_b128 v[224:227], v6 offset:2048
  ds_read_b128 v[228:231], v6 offset:3072
  s_waitcnt lgkmcnt(3)
  v_mfma_f32_32x32x16_bf16 v[128:143], v[112:115], v[32:35], v[192:207]
  s_waitcnt lgkmcnt(2)
  v_mfma_f32_32x32x16_bf16 v[128:143], v[116:119], v[36:39], v[128:143]
  s_nop 11
  v_exp_f32 v128, v128
  v_exp_f32 v129, v129
  v_exp_f32 v130, v130
  v_exp_f32 v131, v131
  v_exp_f32 v132, v132
  v_exp_f32 v133, v133
  v_exp_f32 v134, v134
  v_exp_f32 v135, v135
  v_cvt_pk_bf16_f32 v160, v128, v129
  v_cvt_pk_bf16_f32 v161, v130, v131
  v_exp_f32 v136, v136
  v_exp_f32 v137, v137
  v_exp_f32 v138, v138
  v_exp_f32 v139, v139
  v_cvt_pk_bf16_f32 v162, v132, v133
  v_cvt_pk_bf16_f32 v163, v134, v135
  v_exp_f32 v140, v140
  v_exp_f32 v141, v141
  v_exp_f32 v142, v142
  v_exp_f32 v143, v143
  v_cvt_pk_bf16_f32 v164, v136, v137
  v_cvt_pk_bf16_f32 v165, v138, v139
  v_cvt_pk_bf16_f32 v166, v140, v141
  v_cvt_pk_bf16_f32 v167, v142, v143
  s_waitcnt lgkmcnt(1)
  v_mfma_f32_32x32x16_bf16 v[176:191], v[224:227], v[160:163], v[176:191]
  s_waitcnt lgkmcnt(0)
  v_mfma_f32_32x32x16_bf16 v[176:191], v[228:231], v[164:167], v[176:191]
  s_nop 11
  v_mov_b32 v240, v188
  v_mov_b32 v241, v188
  s_nop 1
  v_permlane32_swap_b32 v240, v241
  s_branch L_p2back
.section .rodata,"a"
.p2align 6
.amdhsa_kernel adaLN_cond__sliding_block__dense_activation_squared_relu__prompt_kernel
  .amdhsa_next_free_vgpr 512
  .amdhsa_next_free_sgpr 102
  .amdhsa_accum_offset 256
  .amdhsa_group_segment_fixed_size 0
  .amdhsa_kernarg_size 104
  .amdhsa_user_sgpr_count 2
  .amdhsa_user_sgpr_kernarg_segment_ptr 1
  .amdhsa_system_sgpr_workgroup_id_x 1
  .amdhsa_float_denorm_mode_32 3
.end_amdhsa_kernel
```
